```python
import torch

def _softmax(x, axis=-1):
    return torch.softmax(x, dim=axis)
def _gelu(x):
    return torch.nn.functional.gelu(x, approximate="tanh")
def _silu(x):
    return torch.nn.functional.silu(x)
def _sigmoid(x):
    return torch.sigmoid(x)
def _layernorm(x, axis=-1, eps=1e-5):
    m = x.mean(dim=axis, keepdim=True)
    v = x.var(dim=axis, keepdim=True, unbiased=False)
    return (x - m) / torch.sqrt(v + eps)
def _scatter_add(tgt, idx, src, axis=0):
    return tgt.clone().index_add_(axis, idx, src)
def _segment_sum(src, seg, n):
    out = torch.zeros((n,) + src.shape[1:], dtype=src.dtype)
    return out.index_add_(0, seg, src)
def _pad(x, pw):
    flat = tuple(v for pair in reversed(pw) for v in pair)
    return torch.nn.functional.pad(x, flat)

kernel_name = 'concat_heads__gqa_block_cached__mha_block_cached__near_ridge'

def setup_inputs():

    _w = (lambda a: (lambda t: t.to(torch.bfloat16) if t.is_floating_point() else t)(torch.as_tensor(a)))
    def _A_setup():
        B, Sq, D = 8, 32, 512
        Hq, Hkv, Sk, Dh = 32, 8, 2048, 128
        assert Hq % Hkv == 0, (Hq, Hkv)
        return {
            "x": _w((lambda *s: torch.randn(*s, dtype=torch.bfloat16) * 0.8)(B, Sq, D)),
            "k_cache": _w((lambda *s: torch.randn(*s, dtype=torch.bfloat16) * 0.8)(B, Hkv, Sk, Dh)),
            "v_cache": _w((lambda *s: torch.randn(*s, dtype=torch.bfloat16) * 0.05)(B, Hkv, Sk, Dh)),
            "wq": _w((lambda *s: torch.randn(*s, dtype=torch.bfloat16) * 0.8)(D, Hq * Dh) * (D ** -0.5)),
            "wo": _w((lambda *s: torch.randn(*s, dtype=torch.bfloat16) * 0.05)(Hq * Dh, D) * ((Hq * Dh) ** -0.5)),
        }
    _A_in = _A_setup()

    def _B_setup():
        B, Sq, D = 8, 32, 512
        H, Sk, Dh = 32, 2048, 128
        return {
            "x": _w((lambda *s: torch.randn(*s, dtype=torch.bfloat16) * 0.8)(B, Sq, D)),
            "k_cache": _w((lambda *s: torch.randn(*s, dtype=torch.bfloat16) * 0.8)(B, H, Sk, Dh)),
            "v_cache": _w((lambda *s: torch.randn(*s, dtype=torch.bfloat16) * 0.05)(B, H, Sk, Dh)),
            "wq": _w((lambda *s: torch.randn(*s, dtype=torch.bfloat16) * 0.8)(D, H * Dh) * (D ** -0.5)),
            "wo": _w((lambda *s: torch.randn(*s, dtype=torch.bfloat16) * 0.05)(H * Dh, D) * ((H * Dh) ** -0.5)),
        }
    _B_in = _B_setup()

    return {
        "A_x": _A_in["x"],
        "A_k_cache": _A_in["k_cache"],
        "A_v_cache": _A_in["v_cache"],
        "A_wq": _A_in["wq"],
        "A_wo": _A_in["wo"],
        "B_x": _B_in["x"],
        "B_k_cache": _B_in["k_cache"],
        "B_v_cache": _B_in["v_cache"],
        "B_wq": _B_in["wq"],
        "B_wo": _B_in["wo"],
    }

def reference(A_x, A_k_cache, A_v_cache, A_wq, A_wo, B_x, B_k_cache, B_v_cache, B_wq, B_wo):
    def _A_ref(x, k_cache, v_cache, wq, wo):
        B, Sq, D = x.shape
        Hq, Dh = 32, 128
        Hkv = k_cache.shape[1]
        rep = Hq // Hkv
        q = (lambda x, *d: x.permute(*d))((x @ wq).reshape(B, Sq, Hq, Dh), 0, 2, 1, 3)
        k = (lambda x, n, axis: torch.repeat_interleave(x, n, dim=axis))(k_cache, rep, axis=1)
        v = (lambda x, n, axis: torch.repeat_interleave(x, n, dim=axis))(v_cache, rep, axis=1)
        scores = torch.einsum("bhqd,bhkd->bhqk", q, k) * (Dh ** -0.5)
        p = _softmax(scores, axis=-1)
        o = torch.einsum("bhqk,bhkd->bhqd", p, v)
        return (lambda x, *d: x.permute(*d))(o, 0, 2, 1, 3).reshape(B, Sq, Hq * Dh) @ wo

    def _B_ref(x, k_cache, v_cache, wq, wo):
        B, Sq, D = x.shape
        H, Dh = 32, 128
        q = (lambda x, *d: x.permute(*d))((x @ wq).reshape(B, Sq, H, Dh), 0, 2, 1, 3)
        scores = torch.einsum("bhqd,bhkd->bhqk", q, k_cache) * (Dh ** -0.5)
        p = _softmax(scores, axis=-1)
        o = torch.einsum("bhqk,bhkd->bhqd", p, v_cache)
        return (lambda x, *d: x.permute(*d))(o, 0, 2, 1, 3).reshape(B, Sq, H * Dh) @ wo

    a = _A_ref(A_x, A_k_cache, A_v_cache, A_wq, A_wo)
    b = _B_ref(B_x, B_k_cache, B_v_cache, B_wq, B_wo)
    return torch.concatenate([a, b], axis=-1)
```

```asm
; @launch grid=(256,1,1) block=(512,1,1) lds=163840
.amdgcn_target "amdgcn-amd-amdhsa--gfx950"
.text
.globl concat_heads__gqa_block_cached__mha_block_cached__near_ridge_kernel
.p2align 8
.type concat_heads__gqa_block_cached__mha_block_cached__near_ridge_kernel,@function
concat_heads__gqa_block_cached__mha_block_cached__near_ridge_kernel:
  s_cmp_ge_u32 s2, 256
  s_cbranch_scc1 K1_END
  s_load_dwordx8 s[8:15], s[0:1], 0
  s_load_dwordx8 s[16:23], s[0:1], 40
  s_load_dwordx2 s[24:25], s[0:1], 96
  v_lshrrev_b32 v1, 6, v0
  v_and_b32 v0, 63, v0
  v_readfirstlane_b32 s3, v1
  s_and_b32 s57, s2, 7
  s_lshr_b32 s58, s2, 3
  s_and_b32 s58, s58, 3
  s_lshr_b32 s6, s2, 5
  s_lshl_b32 s7, s57, 2
  s_add_u32 s7, s7, s58
  s_nop 3
  s_add_u32 s3, s3, s6
  s_and_b32 s3, s3, 7
  s_lshr_b32 s4, s3, 2
  s_and_b32 s5, s3, 3
  s_lshl_b32 s48, s3, 14
  s_add_u32 s49, s48, 8192
  s_lshl_b32 s69, s4, 14
  s_add_u32 s69, s69, 131072
  s_mov_b32 s54, 0x3e0293ee
  s_mov_b32 s55, 0x05040100
  s_mov_b32 s56, 0x07060302
  v_lshrrev_b32 v12, 4, v0
  v_and_b32 v13, 15, v0
  v_xor_b32 v14, v13, v12
  v_xor_b32 v15, 0, v14
  v_lshlrev_b32 v15, 4, v15
  v_lshl_add_u32 v2, v12, 8, v15
  v_lshl_add_u32 v16, v12, 10, v15
  v_xor_b32 v15, 4, v14
  v_lshlrev_b32 v15, 4, v15
  v_lshl_add_u32 v3, v12, 8, v15
  v_lshl_add_u32 v17, v12, 10, v15
  v_xor_b32 v15, 8, v14
  v_lshlrev_b32 v15, 4, v15
  v_lshl_add_u32 v4, v12, 8, v15
  v_lshl_add_u32 v18, v12, 10, v15
  v_xor_b32 v15, 12, v14
  v_lshlrev_b32 v15, 4, v15
  v_lshl_add_u32 v5, v12, 8, v15
  v_lshl_add_u32 v19, v12, 10, v15
  v_lshlrev_b32 v15, 2, v12
  v_xor_b32 v15, v13, v15
  v_lshlrev_b32 v15, 4, v15
  v_lshl_add_u32 v6, v12, 8, v15
  v_lshlrev_b32 v20, 4, v13
  v_lshl_add_u32 v20, v12, 16, v20
  v_lshlrev_b32 v21, 4, v14
  v_lshl_add_u32 v21, v13, 8, v21
  v_add_u32 v21, s49, v21
  v_and_b32 v22, 31, v0
  v_and_b32 v23, 0x13, v22
  v_and_b32 v24, 4, v22
  v_lshlrev_b32 v24, 1, v24
  v_or_b32 v23, v23, v24
  v_and_b32 v24, 8, v22
  v_lshrrev_b32 v24, 1, v24
  v_or_b32 v23, v23, v24
  v_lshrrev_b32 v24, 5, v0
  v_and_b32 v25, 15, v23
  v_xor_b32 v25, v25, v24
  v_lshlrev_b32 v25, 4, v25
  v_lshl_add_u32 v25, v23, 8, v25
  v_add_u32 v7, s48, v25
  v_lshrrev_b32 v22, 1, v12
  v_lshlrev_b32 v22, 3, v22
  v_lshrrev_b32 v23, 2, v13
  v_add_u32 v22, v22, v23
  v_lshlrev_b32 v22, 8, v22
  v_and_b32 v24, 1, v12
  v_lshlrev_b32 v24, 5, v24
  v_add_u32 v22, v22, v24
  v_and_b32 v24, 2, v13
  v_lshlrev_b32 v24, 3, v24
  v_add_u32 v22, v22, v24
  v_and_b32 v24, 1, v13
  v_lshlrev_b32 v24, 3, v24
  v_add_u32 v22, v22, v24
  v_add_u32 v22, s49, v22
  s_add_u32 s52, s5, 0
  s_and_b32 s52, s52, 3
  v_xor_b32 v24, s52, v23
  v_lshl_add_u32 v8, v24, 6, v22
  s_add_u32 s52, s5, 1
  s_and_b32 s52, s52, 3
  v_xor_b32 v24, s52, v23
  v_lshl_add_u32 v9, v24, 6, v22
  s_add_u32 s52, s5, 2
  s_and_b32 s52, s52, 3
  v_xor_b32 v24, s52, v23
  v_lshl_add_u32 v10, v24, 6, v22
  s_add_u32 s52, s5, 3
  s_and_b32 s52, s52, 3
  v_xor_b32 v24, s52, v23
  v_lshl_add_u32 v11, v24, 6, v22
  s_waitcnt lgkmcnt(0)
  s_cmp_eq_u32 s4, 0
  s_cselect_b32 s60, s16, s8
  s_cselect_b32 s61, s17, s9
  s_cselect_b32 s62, s18, s10
  s_cselect_b32 s63, s19, s11
  s_cselect_b32 s64, s20, s12
  s_cselect_b32 s65, s21, s13
  s_cselect_b32 s66, s22, s14
  s_cselect_b32 s67, s23, s15
  s_lshl_b32 s52, s6, 5
  s_add_u32 s52, s52, s7
  s_xor_b32 s59, s6, 4
  s_lshl_b32 s59, s59, 3
  s_add_u32 s59, s59, s57
  s_cmp_eq_u32 s4, 0
  s_cselect_b32 s52, s52, s59
  s_lshl_b32 s52, s52, 19
  s_mov_b32 s36, s60
  s_and_b32 s37, s61, 0xffff
  s_mov_b32 s38, 262144
  s_mov_b32 s39, 0x20000
  s_mov_b32 s40, s66
  s_and_b32 s41, s67, 0xffff
  s_mov_b32 s42, 4194304
  s_mov_b32 s43, 0x20000
  s_add_u32 s28, s62, s52
  s_addc_u32 s29, s63, 0
  s_and_b32 s29, s29, 0xffff
  s_mov_b32 s30, 524288
  s_mov_b32 s31, 0x20000
  s_add_u32 s32, s64, s52
  s_addc_u32 s33, s65, 0
  s_and_b32 s33, s33, 0xffff
  s_mov_b32 s34, 524288
  s_mov_b32 s35, 0x20000
  s_mov_b32 s44, s24
  s_and_b32 s45, s25, 0xffff
  s_mov_b32 s46, 4194304
  s_mov_b32 s47, 0x20000
  s_load_dwordx2 s[70:71], s[0:1], 32
  s_load_dwordx2 s[76:77], s[0:1], 72
  s_load_dwordx4 s[8:11], s[0:1], 80
  s_setprio 3
  s_mul_i32 s59, s4, 4
  s_xor_b32 s52, s6, s59
  s_lshl_b32 s52, s52, 15
  s_lshl_b32 s59, s5, 8
  s_add_u32 s52, s52, s59
  s_add_u32 m0, s49, 0
  s_add_u32 s59, s52, 0
  buffer_load_dwordx4 v16, s[36:39], s59 offen  lds
  s_add_u32 m0, s49, 1024
  s_add_u32 s59, s52, 4096
  buffer_load_dwordx4 v17, s[36:39], s59 offen  lds
  s_add_u32 m0, s49, 2048
  s_add_u32 s59, s52, 8192
  buffer_load_dwordx4 v18, s[36:39], s59 offen  lds
  s_add_u32 m0, s49, 3072
  s_add_u32 s59, s52, 12288
  buffer_load_dwordx4 v19, s[36:39], s59 offen  lds
  s_add_u32 m0, s49, 4096
  s_add_u32 s59, s52, 16384
  buffer_load_dwordx4 v16, s[36:39], s59 offen  lds
  s_add_u32 m0, s49, 5120
  s_add_u32 s59, s52, 20480
  buffer_load_dwordx4 v17, s[36:39], s59 offen  lds
  s_add_u32 m0, s49, 6144
  s_add_u32 s59, s52, 24576
  buffer_load_dwordx4 v18, s[36:39], s59 offen  lds
  s_add_u32 m0, s49, 7168
  s_add_u32 s59, s52, 28672
  buffer_load_dwordx4 v19, s[36:39], s59 offen  lds
  s_lshl_b32 s52, s5, 20
  s_lshl_b32 s59, s7, 8
  s_add_u32 s52, s52, s59
  v_mov_b32 v15, v20
  s_mov_b32 s26, s52
  s_lshr_b32 s68, s6, 0
  s_add_u32 s68, s68, 0
  s_and_b32 s68, s68, 3
  s_lshl_b32 s68, s68, 18
  s_add_u32 s68, s68, s26
  s_add_u32 s59, s68, 0
  buffer_load_dwordx4 v[128:131], v15, s[40:43], s59 offen
  s_add_u32 s59, s68, 8192
  buffer_load_dwordx4 v[132:135], v15, s[40:43], s59 offen
  s_add_u32 s59, s68, 16384
  buffer_load_dwordx4 v[136:139], v15, s[40:43], s59 offen
  s_add_u32 s59, s68, 24576
  buffer_load_dwordx4 v[140:143], v15, s[40:43], s59 offen
  s_add_u32 s59, s68, 32768
  buffer_load_dwordx4 v[144:147], v15, s[40:43], s59 offen
  s_add_u32 s59, s68, 40960
  buffer_load_dwordx4 v[148:151], v15, s[40:43], s59 offen
  s_add_u32 s59, s68, 49152
  buffer_load_dwordx4 v[152:155], v15, s[40:43], s59 offen
  s_add_u32 s59, s68, 57344
  buffer_load_dwordx4 v[156:159], v15, s[40:43], s59 offen
  s_setprio 2
  s_lshr_b32 s68, s6, 0
  s_add_u32 s68, s68, 1
  s_and_b32 s68, s68, 3
  s_lshl_b32 s68, s68, 18
  s_add_u32 s68, s68, s26
  s_add_u32 s59, s68, 0
  buffer_load_dwordx4 v[160:163], v15, s[40:43], s59 offen
  s_add_u32 s59, s68, 8192
  buffer_load_dwordx4 v[164:167], v15, s[40:43], s59 offen
  s_add_u32 s59, s68, 16384
  buffer_load_dwordx4 v[168:171], v15, s[40:43], s59 offen
  s_add_u32 s59, s68, 24576
  buffer_load_dwordx4 v[172:175], v15, s[40:43], s59 offen
  s_add_u32 s59, s68, 32768
  buffer_load_dwordx4 v[176:179], v15, s[40:43], s59 offen
  s_add_u32 s59, s68, 40960
  buffer_load_dwordx4 v[180:183], v15, s[40:43], s59 offen
  s_add_u32 s59, s68, 49152
  buffer_load_dwordx4 v[184:187], v15, s[40:43], s59 offen
  s_add_u32 s59, s68, 57344
  buffer_load_dwordx4 v[188:191], v15, s[40:43], s59 offen
  s_setprio 1
  s_lshl_b32 s50, s5, 13
  s_mov_b32 s51, s50
  s_waitcnt vmcnt(16)
  s_lshr_b32 s68, s6, 0
  s_add_u32 s68, s68, 0
  s_and_b32 s68, s68, 3
  s_lshl_b32 s68, s68, 6
  v_xor_b32 v22, s68, v21
  ds_read_b128 v[32:35], v22 offset:0
  ds_read_b128 v[36:39], v22 offset:4096
  s_lshr_b32 s68, s6, 0
  s_add_u32 s68, s68, 1
  s_and_b32 s68, s68, 3
  s_lshl_b32 s68, s68, 6
  v_xor_b32 v22, s68, v21
  ds_read_b128 v[40:43], v22 offset:0
  ds_read_b128 v[44:47], v22 offset:4096
  s_lshr_b32 s68, s6, 0
  s_add_u32 s68, s68, 2
  s_and_b32 s68, s68, 3
  s_lshl_b32 s68, s68, 6
  v_xor_b32 v22, s68, v21
  ds_read_b128 v[48:51], v22 offset:0
  ds_read_b128 v[52:55], v22 offset:4096
  s_lshr_b32 s68, s6, 0
  s_add_u32 s68, s68, 3
  s_and_b32 s68, s68, 3
  s_lshl_b32 s68, s68, 6
  v_xor_b32 v22, s68, v21
  ds_read_b128 v[56:59], v22 offset:0
  ds_read_b128 v[60:63], v22 offset:4096
  s_waitcnt lgkmcnt(0)
  s_waitcnt vmcnt(8)
  v_perm_b32 v16, v132, v128, s55
  v_perm_b32 v20, v132, v128, s56
  v_perm_b32 v17, v140, v136, s55
  v_perm_b32 v21, v140, v136, s56
  v_perm_b32 v18, v148, v144, s55
  v_perm_b32 v22, v148, v144, s56
  v_perm_b32 v19, v156, v152, s55
  v_perm_b32 v23, v156, v152, s56
  s_nop 1
  v_mfma_f32_16x16x32_bf16 v[64:67], v[16:19], v[32:35], 0
  v_mfma_f32_16x16x32_bf16 v[68:71], v[16:19], v[36:39], 0
  v_mfma_f32_16x16x32_bf16 v[72:75], v[20:23], v[32:35], 0
  v_mfma_f32_16x16x32_bf16 v[76:79], v[20:23], v[36:39], 0
  v_perm_b32 v24, v133, v129, s55
  v_perm_b32 v28, v133, v129, s56
  v_perm_b32 v25, v141, v137, s55
  v_perm_b32 v29, v141, v137, s56
  v_perm_b32 v26, v149, v145, s55
  v_perm_b32 v30, v149, v145, s56
  v_perm_b32 v27, v157, v153, s55
  v_perm_b32 v31, v157, v153, s56
  s_nop 1
  v_mfma_f32_16x16x32_bf16 v[80:83], v[24:27], v[32:35], 0
  v_mfma_f32_16x16x32_bf16 v[84:87], v[24:27], v[36:39], 0
  v_mfma_f32_16x16x32_bf16 v[88:91], v[28:31], v[32:35], 0
  v_mfma_f32_16x16x32_bf16 v[92:95], v[28:31], v[36:39], 0
  v_perm_b32 v16, v134, v130, s55
  v_perm_b32 v20, v134, v130, s56
  v_perm_b32 v17, v142, v138, s55
  v_perm_b32 v21, v142, v138, s56
  v_perm_b32 v18, v150, v146, s55
  v_perm_b32 v22, v150, v146, s56
  v_perm_b32 v19, v158, v154, s55
  v_perm_b32 v23, v158, v154, s56
  s_nop 1
  v_mfma_f32_16x16x32_bf16 v[96:99], v[16:19], v[32:35], 0
  v_mfma_f32_16x16x32_bf16 v[100:103], v[16:19], v[36:39], 0
  v_mfma_f32_16x16x32_bf16 v[104:107], v[20:23], v[32:35], 0
  v_mfma_f32_16x16x32_bf16 v[108:111], v[20:23], v[36:39], 0
  v_perm_b32 v24, v135, v131, s55
  v_perm_b32 v28, v135, v131, s56
  v_perm_b32 v25, v143, v139, s55
  v_perm_b32 v29, v143, v139, s56
  v_perm_b32 v26, v151, v147, s55
  v_perm_b32 v30, v151, v147, s56
  v_perm_b32 v27, v159, v155, s55
  v_perm_b32 v31, v159, v155, s56
  s_nop 1
  v_mfma_f32_16x16x32_bf16 v[112:115], v[24:27], v[32:35], 0
  v_mfma_f32_16x16x32_bf16 v[116:119], v[24:27], v[36:39], 0
  v_mfma_f32_16x16x32_bf16 v[120:123], v[28:31], v[32:35], 0
  v_mfma_f32_16x16x32_bf16 v[124:127], v[28:31], v[36:39], 0
  s_lshr_b32 s68, s6, 0
  s_add_u32 s68, s68, 2
  s_and_b32 s68, s68, 3
  s_lshl_b32 s68, s68, 18
  s_add_u32 s68, s68, s26
  s_add_u32 s59, s68, 0
  buffer_load_dwordx4 v[192:195], v15, s[40:43], s59 offen
  s_add_u32 s59, s68, 8192
  buffer_load_dwordx4 v[196:199], v15, s[40:43], s59 offen
  s_add_u32 s59, s68, 16384
  buffer_load_dwordx4 v[200:203], v15, s[40:43], s59 offen
  s_add_u32 s59, s68, 24576
  buffer_load_dwordx4 v[204:207], v15, s[40:43], s59 offen
  s_add_u32 s59, s68, 32768
  buffer_load_dwordx4 v[208:211], v15, s[40:43], s59 offen
  s_add_u32 s59, s68, 40960
  buffer_load_dwordx4 v[212:215], v15, s[40:43], s59 offen
  s_add_u32 s59, s68, 49152
  buffer_load_dwordx4 v[216:219], v15, s[40:43], s59 offen
  s_add_u32 s59, s68, 57344
  buffer_load_dwordx4 v[220:223], v15, s[40:43], s59 offen
  s_setprio 0
  s_waitcnt vmcnt(8)
  v_perm_b32 v16, v164, v160, s55
  v_perm_b32 v20, v164, v160, s56
  v_perm_b32 v17, v172, v168, s55
  v_perm_b32 v21, v172, v168, s56
  v_perm_b32 v18, v180, v176, s55
  v_perm_b32 v22, v180, v176, s56
  v_perm_b32 v19, v188, v184, s55
  v_perm_b32 v23, v188, v184, s56
  s_nop 1
  v_mfma_f32_16x16x32_bf16 v[64:67], v[16:19], v[40:43], v[64:67]
  v_mfma_f32_16x16x32_bf16 v[68:71], v[16:19], v[44:47], v[68:71]
  v_mfma_f32_16x16x32_bf16 v[72:75], v[20:23], v[40:43], v[72:75]
  v_mfma_f32_16x16x32_bf16 v[76:79], v[20:23], v[44:47], v[76:79]
  v_perm_b32 v24, v165, v161, s55
  v_perm_b32 v28, v165, v161, s56
  v_perm_b32 v25, v173, v169, s55
  v_perm_b32 v29, v173, v169, s56
  v_perm_b32 v26, v181, v177, s55
  v_perm_b32 v30, v181, v177, s56
  v_perm_b32 v27, v189, v185, s55
  v_perm_b32 v31, v189, v185, s56
  s_nop 1
  v_mfma_f32_16x16x32_bf16 v[80:83], v[24:27], v[40:43], v[80:83]
  v_mfma_f32_16x16x32_bf16 v[84:87], v[24:27], v[44:47], v[84:87]
  v_mfma_f32_16x16x32_bf16 v[88:91], v[28:31], v[40:43], v[88:91]
  v_mfma_f32_16x16x32_bf16 v[92:95], v[28:31], v[44:47], v[92:95]
  v_perm_b32 v16, v166, v162, s55
  v_perm_b32 v20, v166, v162, s56
  v_perm_b32 v17, v174, v170, s55
  v_perm_b32 v21, v174, v170, s56
  v_perm_b32 v18, v182, v178, s55
  v_perm_b32 v22, v182, v178, s56
  v_perm_b32 v19, v190, v186, s55
  v_perm_b32 v23, v190, v186, s56
  s_nop 1
  v_mfma_f32_16x16x32_bf16 v[96:99], v[16:19], v[40:43], v[96:99]
  v_mfma_f32_16x16x32_bf16 v[100:103], v[16:19], v[44:47], v[100:103]
  v_mfma_f32_16x16x32_bf16 v[104:107], v[20:23], v[40:43], v[104:107]
  v_mfma_f32_16x16x32_bf16 v[108:111], v[20:23], v[44:47], v[108:111]
  v_perm_b32 v24, v167, v163, s55
  v_perm_b32 v28, v167, v163, s56
  v_perm_b32 v25, v175, v171, s55
  v_perm_b32 v29, v175, v171, s56
  v_perm_b32 v26, v183, v179, s55
  v_perm_b32 v30, v183, v179, s56
  v_perm_b32 v27, v191, v187, s55
  v_perm_b32 v31, v191, v187, s56
  s_nop 1
  v_mfma_f32_16x16x32_bf16 v[112:115], v[24:27], v[40:43], v[112:115]
  v_mfma_f32_16x16x32_bf16 v[116:119], v[24:27], v[44:47], v[116:119]
  v_mfma_f32_16x16x32_bf16 v[120:123], v[28:31], v[40:43], v[120:123]
  v_mfma_f32_16x16x32_bf16 v[124:127], v[28:31], v[44:47], v[124:127]
  s_lshr_b32 s68, s6, 0
  s_add_u32 s68, s68, 3
  s_and_b32 s68, s68, 3
  s_lshl_b32 s68, s68, 18
  s_add_u32 s68, s68, s26
  s_add_u32 s59, s68, 0
  buffer_load_dwordx4 v[224:227], v15, s[40:43], s59 offen
  s_add_u32 s59, s68, 8192
  buffer_load_dwordx4 v[228:231], v15, s[40:43], s59 offen
  s_add_u32 s59, s68, 16384
  buffer_load_dwordx4 v[232:235], v15, s[40:43], s59 offen
  s_add_u32 s59, s68, 24576
  buffer_load_dwordx4 v[236:239], v15, s[40:43], s59 offen
  s_add_u32 s59, s68, 32768
  buffer_load_dwordx4 v[240:243], v15, s[40:43], s59 offen
  s_add_u32 s59, s68, 40960
  buffer_load_dwordx4 v[244:247], v15, s[40:43], s59 offen
  s_add_u32 s59, s68, 49152
  buffer_load_dwordx4 v[248:251], v15, s[40:43], s59 offen
  s_add_u32 s59, s68, 57344
  buffer_load_dwordx4 v[252:255], v15, s[40:43], s59 offen
  s_setprio 0
  s_waitcnt vmcnt(8)
  v_perm_b32 v16, v196, v192, s55
  v_perm_b32 v20, v196, v192, s56
  v_perm_b32 v17, v204, v200, s55
  v_perm_b32 v21, v204, v200, s56
  v_perm_b32 v18, v212, v208, s55
  v_perm_b32 v22, v212, v208, s56
  v_perm_b32 v19, v220, v216, s55
  v_perm_b32 v23, v220, v216, s56
  s_nop 1
  v_mfma_f32_16x16x32_bf16 v[64:67], v[16:19], v[48:51], v[64:67]
  v_mfma_f32_16x16x32_bf16 v[68:71], v[16:19], v[52:55], v[68:71]
  v_mfma_f32_16x16x32_bf16 v[72:75], v[20:23], v[48:51], v[72:75]
  v_mfma_f32_16x16x32_bf16 v[76:79], v[20:23], v[52:55], v[76:79]
  v_perm_b32 v24, v197, v193, s55
  v_perm_b32 v28, v197, v193, s56
  v_perm_b32 v25, v205, v201, s55
  v_perm_b32 v29, v205, v201, s56
  v_perm_b32 v26, v213, v209, s55
  v_perm_b32 v30, v213, v209, s56
  v_perm_b32 v27, v221, v217, s55
  v_perm_b32 v31, v221, v217, s56
  s_nop 1
  v_mfma_f32_16x16x32_bf16 v[80:83], v[24:27], v[48:51], v[80:83]
  v_mfma_f32_16x16x32_bf16 v[84:87], v[24:27], v[52:55], v[84:87]
  v_mfma_f32_16x16x32_bf16 v[88:91], v[28:31], v[48:51], v[88:91]
  v_mfma_f32_16x16x32_bf16 v[92:95], v[28:31], v[52:55], v[92:95]
  v_perm_b32 v16, v198, v194, s55
  v_perm_b32 v20, v198, v194, s56
  v_perm_b32 v17, v206, v202, s55
  v_perm_b32 v21, v206, v202, s56
  v_perm_b32 v18, v214, v210, s55
  v_perm_b32 v22, v214, v210, s56
  v_perm_b32 v19, v222, v218, s55
  v_perm_b32 v23, v222, v218, s56
  s_nop 1
  v_mfma_f32_16x16x32_bf16 v[96:99], v[16:19], v[48:51], v[96:99]
  v_mfma_f32_16x16x32_bf16 v[100:103], v[16:19], v[52:55], v[100:103]
  v_mfma_f32_16x16x32_bf16 v[104:107], v[20:23], v[48:51], v[104:107]
  v_mfma_f32_16x16x32_bf16 v[108:111], v[20:23], v[52:55], v[108:111]
  v_perm_b32 v24, v199, v195, s55
  v_perm_b32 v28, v199, v195, s56
  v_perm_b32 v25, v207, v203, s55
  v_perm_b32 v29, v207, v203, s56
  v_perm_b32 v26, v215, v211, s55
  v_perm_b32 v30, v215, v211, s56
  v_perm_b32 v27, v223, v219, s55
  v_perm_b32 v31, v223, v219, s56
  s_nop 1
  v_mfma_f32_16x16x32_bf16 v[112:115], v[24:27], v[48:51], v[112:115]
  v_mfma_f32_16x16x32_bf16 v[116:119], v[24:27], v[52:55], v[116:119]
  v_mfma_f32_16x16x32_bf16 v[120:123], v[28:31], v[48:51], v[120:123]
  v_mfma_f32_16x16x32_bf16 v[124:127], v[28:31], v[52:55], v[124:127]
  s_waitcnt vmcnt(0)
  v_perm_b32 v16, v228, v224, s55
  v_perm_b32 v20, v228, v224, s56
  v_perm_b32 v17, v236, v232, s55
  v_perm_b32 v21, v236, v232, s56
  v_perm_b32 v18, v244, v240, s55
  v_perm_b32 v22, v244, v240, s56
  v_perm_b32 v19, v252, v248, s55
  v_perm_b32 v23, v252, v248, s56
  s_nop 1
  v_mfma_f32_16x16x32_bf16 v[64:67], v[16:19], v[56:59], v[64:67]
  v_mfma_f32_16x16x32_bf16 v[68:71], v[16:19], v[60:63], v[68:71]
  v_mfma_f32_16x16x32_bf16 v[72:75], v[20:23], v[56:59], v[72:75]
  v_mfma_f32_16x16x32_bf16 v[76:79], v[20:23], v[60:63], v[76:79]
  v_perm_b32 v24, v229, v225, s55
  v_perm_b32 v28, v229, v225, s56
  v_perm_b32 v25, v237, v233, s55
  v_perm_b32 v29, v237, v233, s56
  v_perm_b32 v26, v245, v241, s55
  v_perm_b32 v30, v245, v241, s56
  v_perm_b32 v27, v253, v249, s55
  v_perm_b32 v31, v253, v249, s56
  s_nop 1
  v_mfma_f32_16x16x32_bf16 v[80:83], v[24:27], v[56:59], v[80:83]
  v_mfma_f32_16x16x32_bf16 v[84:87], v[24:27], v[60:63], v[84:87]
  v_mfma_f32_16x16x32_bf16 v[88:91], v[28:31], v[56:59], v[88:91]
  v_mfma_f32_16x16x32_bf16 v[92:95], v[28:31], v[60:63], v[92:95]
  v_perm_b32 v16, v230, v226, s55
  v_perm_b32 v20, v230, v226, s56
  v_perm_b32 v17, v238, v234, s55
  v_perm_b32 v21, v238, v234, s56
  v_perm_b32 v18, v246, v242, s55
  v_perm_b32 v22, v246, v242, s56
  v_perm_b32 v19, v254, v250, s55
  v_perm_b32 v23, v254, v250, s56
  s_nop 1
  v_mfma_f32_16x16x32_bf16 v[96:99], v[16:19], v[56:59], v[96:99]
  v_mfma_f32_16x16x32_bf16 v[100:103], v[16:19], v[60:63], v[100:103]
  v_mfma_f32_16x16x32_bf16 v[104:107], v[20:23], v[56:59], v[104:107]
  v_mfma_f32_16x16x32_bf16 v[108:111], v[20:23], v[60:63], v[108:111]
  v_perm_b32 v24, v231, v227, s55
  v_perm_b32 v28, v231, v227, s56
  v_perm_b32 v25, v239, v235, s55
  v_perm_b32 v29, v239, v235, s56
  v_perm_b32 v26, v247, v243, s55
  v_perm_b32 v30, v247, v243, s56
  v_perm_b32 v27, v255, v251, s55
  v_perm_b32 v31, v255, v251, s56
  s_nop 1
  v_mfma_f32_16x16x32_bf16 v[112:115], v[24:27], v[56:59], v[112:115]
  v_mfma_f32_16x16x32_bf16 v[116:119], v[24:27], v[60:63], v[116:119]
  v_mfma_f32_16x16x32_bf16 v[120:123], v[28:31], v[56:59], v[120:123]
  v_mfma_f32_16x16x32_bf16 v[124:127], v[28:31], v[60:63], v[124:127]
  s_cmp_eq_u32 s4, 0
  s_cbranch_scc1 DMHB_1
  s_mov_b32 m0, s48
  s_nop 0
  buffer_load_dwordx4 v2, s[28:31], s50 offen offset:0 sc0 lds
  buffer_load_dwordx4 v3, s[28:31], s50 offen offset:1024 sc0 lds
  buffer_load_dwordx4 v4, s[28:31], s50 offen offset:2048 sc0 lds
  buffer_load_dwordx4 v5, s[28:31], s50 offen offset:3072 sc0 lds
  s_branch DMHE_1
DMHB_1:
  s_mov_b32 m0, s48
  s_nop 0
  buffer_load_dwordx4 v2, s[28:31], s50 offen offset:0 nt lds
  buffer_load_dwordx4 v3, s[28:31], s50 offen offset:1024 nt lds
  buffer_load_dwordx4 v4, s[28:31], s50 offen offset:2048 nt lds
  buffer_load_dwordx4 v5, s[28:31], s50 offen offset:3072 nt lds
DMHE_1:
  v_lshrrev_b32 v22, 4, v0
  v_and_b32 v23, 15, v0
  v_and_b32 v24, 7, v23
  v_lshlrev_b32 v24, 4, v24
  v_lshl_add_u32 v24, v22, 7, v24
  v_lshl_add_u32 v24, v23, 9, v24
  v_add_u32 v25, s49, v24
  s_lshl_b32 s52, s4, 16
  s_add_u32 s52, s52, 8192
  v_add_u32 v26, s52, v24
  s_lshl_b32 s59, s5, 5
  v_xor_b32 v26, s59, v26
  v_xor_b32 v27, 16, v26
  v_lshlrev_b32 v28, 2, v22
  v_xor_b32 v28, v28, v23
  v_lshlrev_b32 v28, 4, v28
  v_lshl_add_u32 v28, v23, 8, v28
  s_lshl_b32 s59, s5, 2
  s_add_u32 s59, s59, s69
  v_add_u32 v28, s59, v28
  s_nop 7
  v_xor_b32 v29, 0, v25
  ds_write_b128 v29, v[64:67]
  v_xor_b32 v29, 16, v25
  ds_write_b128 v29, v[72:75]
  v_xor_b32 v29, 32, v25
  ds_write_b128 v29, v[80:83]
  v_xor_b32 v29, 48, v25
  ds_write_b128 v29, v[88:91]
  v_xor_b32 v29, 64, v25
  ds_write_b128 v29, v[96:99]
  v_xor_b32 v29, 80, v25
  ds_write_b128 v29, v[104:107]
  v_xor_b32 v29, 96, v25
  ds_write_b128 v29, v[112:115]
  v_xor_b32 v29, 112, v25
  ds_write_b128 v29, v[120:123]
  s_waitcnt lgkmcnt(0)
  s_barrier
  ds_read_b128 v[128:131], v26 offset:0
  ds_read_b128 v[132:135], v27 offset:0
  ds_read_b128 v[136:139], v26 offset:16384
  ds_read_b128 v[140:143], v27 offset:16384
  ds_read_b128 v[144:147], v26 offset:32768
  ds_read_b128 v[148:151], v27 offset:32768
  ds_read_b128 v[152:155], v26 offset:49152
  ds_read_b128 v[156:159], v27 offset:49152
  s_waitcnt lgkmcnt(0)
  v_add_f32 v128, v128, v136
  v_add_f32 v144, v144, v152
  v_add_f32 v129, v129, v137
  v_add_f32 v145, v145, v153
  v_add_f32 v130, v130, v138
  v_add_f32 v146, v146, v154
  v_add_f32 v131, v131, v139
  v_add_f32 v147, v147, v155
  v_add_f32 v132, v132, v140
  v_add_f32 v148, v148, v156
  v_add_f32 v133, v133, v141
  v_add_f32 v149, v149, v157
  v_add_f32 v134, v134, v142
  v_add_f32 v150, v150, v158
  v_add_f32 v135, v135, v143
  v_add_f32 v151, v151, v159
  v_add_f32 v128, v128, v144
  v_add_f32 v129, v129, v145
  v_add_f32 v130, v130, v146
  v_add_f32 v131, v131, v147
  v_add_f32 v132, v132, v148
  v_add_f32 v133, v133, v149
  v_add_f32 v134, v134, v150
  v_add_f32 v135, v135, v151
  v_cvt_pk_bf16_f32 v160, v128, v132
  v_cvt_pk_bf16_f32 v161, v129, v133
  v_cvt_pk_bf16_f32 v162, v130, v134
  v_cvt_pk_bf16_f32 v163, v131, v135
  v_xor_b32 v29, 0, v28
  ds_write_b32 v29, v160 offset:0
  v_xor_b32 v29, 16, v28
  ds_write_b32 v29, v161 offset:0
  v_xor_b32 v29, 32, v28
  ds_write_b32 v29, v162 offset:0
  v_xor_b32 v29, 48, v28
  ds_write_b32 v29, v163 offset:0
  s_waitcnt lgkmcnt(0)
  s_barrier
  v_xor_b32 v29, 0, v25
  ds_write_b128 v29, v[68:71]
  v_xor_b32 v29, 16, v25
  ds_write_b128 v29, v[76:79]
  v_xor_b32 v29, 32, v25
  ds_write_b128 v29, v[84:87]
  v_xor_b32 v29, 48, v25
  ds_write_b128 v29, v[92:95]
  v_xor_b32 v29, 64, v25
  ds_write_b128 v29, v[100:103]
  v_xor_b32 v29, 80, v25
  ds_write_b128 v29, v[108:111]
  v_xor_b32 v29, 96, v25
  ds_write_b128 v29, v[116:119]
  v_xor_b32 v29, 112, v25
  ds_write_b128 v29, v[124:127]
  s_waitcnt lgkmcnt(0)
  s_barrier
  s_cmp_eq_u32 s4, 0
  s_cbranch_scc1 DMHB_2
  s_add_u32 m0, s48, 4096
  s_add_u32 s52, s50, 4096
  s_add_u32 s50, s50, 32768
  buffer_load_dwordx4 v2, s[28:31], s52 offen offset:0 sc0 lds
  buffer_load_dwordx4 v3, s[28:31], s52 offen offset:1024 sc0 lds
  buffer_load_dwordx4 v4, s[28:31], s52 offen offset:2048 sc0 lds
  buffer_load_dwordx4 v5, s[28:31], s52 offen offset:3072 sc0 lds
  s_branch DMHE_2
DMHB_2:
  s_add_u32 m0, s48, 4096
  s_add_u32 s52, s50, 4096
  s_add_u32 s50, s50, 32768
  buffer_load_dwordx4 v2, s[28:31], s52 offen offset:0 nt lds
  buffer_load_dwordx4 v3, s[28:31], s52 offen offset:1024 nt lds
  buffer_load_dwordx4 v4, s[28:31], s52 offen offset:2048 nt lds
  buffer_load_dwordx4 v5, s[28:31], s52 offen offset:3072 nt lds
DMHE_2:
  ds_read_b128 v[128:131], v26 offset:0
  ds_read_b128 v[132:135], v27 offset:0
  ds_read_b128 v[136:139], v26 offset:16384
  ds_read_b128 v[140:143], v27 offset:16384
  ds_read_b128 v[144:147], v26 offset:32768
  ds_read_b128 v[148:151], v27 offset:32768
  ds_read_b128 v[152:155], v26 offset:49152
  ds_read_b128 v[156:159], v27 offset:49152
  s_waitcnt lgkmcnt(0)
  v_add_f32 v128, v128, v136
  v_add_f32 v144, v144, v152
  v_add_f32 v129, v129, v137
  v_add_f32 v145, v145, v153
  v_add_f32 v130, v130, v138
  v_add_f32 v146, v146, v154
  v_add_f32 v131, v131, v139
  v_add_f32 v147, v147, v155
  v_add_f32 v132, v132, v140
  v_add_f32 v148, v148, v156
  v_add_f32 v133, v133, v141
  v_add_f32 v149, v149, v157
  v_add_f32 v134, v134, v142
  v_add_f32 v150, v150, v158
  v_add_f32 v135, v135, v143
  v_add_f32 v151, v151, v159
  v_add_f32 v128, v128, v144
  v_add_f32 v129, v129, v145
  v_add_f32 v130, v130, v146
  v_add_f32 v131, v131, v147
  v_add_f32 v132, v132, v148
  v_add_f32 v133, v133, v149
  v_add_f32 v134, v134, v150
  v_add_f32 v135, v135, v151
  v_cvt_pk_bf16_f32 v160, v128, v132
  v_cvt_pk_bf16_f32 v161, v129, v133
  v_cvt_pk_bf16_f32 v162, v130, v134
  v_cvt_pk_bf16_f32 v163, v131, v135
  v_xor_b32 v29, 0, v28
  ds_write_b32 v29, v160 offset:4096
  v_xor_b32 v29, 16, v28
  ds_write_b32 v29, v161 offset:4096
  v_xor_b32 v29, 32, v28
  ds_write_b32 v29, v162 offset:4096
  v_xor_b32 v29, 48, v28
  ds_write_b32 v29, v163 offset:4096
  s_waitcnt lgkmcnt(0)
  s_barrier
  s_cmp_eq_u32 s4, 0
  s_cbranch_scc1 DMAB_3
  s_mov_b32 m0, s49
  s_add_u32 s52, s51, 4096
  buffer_load_dwordx4 v6, s[32:35], s51 offen offset:0 sc0 lds
  buffer_load_dwordx4 v6, s[32:35], s51 offen offset:1024 sc0 lds
  buffer_load_dwordx4 v6, s[32:35], s51 offen offset:2048 sc0 lds
  buffer_load_dwordx4 v6, s[32:35], s51 offen offset:3072 sc0 lds
  s_add_u32 m0, s49, 4096
  s_add_u32 s51, s51, 32768
  buffer_load_dwordx4 v6, s[32:35], s52 offen offset:0 sc0 lds
  buffer_load_dwordx4 v6, s[32:35], s52 offen offset:1024 sc0 lds
  buffer_load_dwordx4 v6, s[32:35], s52 offen offset:2048 sc0 lds
  buffer_load_dwordx4 v6, s[32:35], s52 offen offset:3072 sc0 lds
  s_branch DMAE_3
DMAB_3:
  s_mov_b32 m0, s49
  s_add_u32 s52, s51, 4096
  buffer_load_dwordx4 v6, s[32:35], s51 offen offset:0 nt lds
  buffer_load_dwordx4 v6, s[32:35], s51 offen offset:1024 nt lds
  buffer_load_dwordx4 v6, s[32:35], s51 offen offset:2048 nt lds
  buffer_load_dwordx4 v6, s[32:35], s51 offen offset:3072 nt lds
  s_add_u32 m0, s49, 4096
  s_add_u32 s51, s51, 32768
  buffer_load_dwordx4 v6, s[32:35], s52 offen offset:0 nt lds
  buffer_load_dwordx4 v6, s[32:35], s52 offen offset:1024 nt lds
  buffer_load_dwordx4 v6, s[32:35], s52 offen offset:2048 nt lds
  buffer_load_dwordx4 v6, s[32:35], s52 offen offset:3072 nt lds
DMAE_3:
  v_and_b32 v22, 31, v0
  v_lshrrev_b32 v23, 5, v0
  v_and_b32 v24, 15, v22
  v_xor_b32 v24, v24, v23
  v_lshlrev_b32 v24, 4, v24
  v_lshl_add_u32 v24, v22, 8, v24
  v_add_u32 v24, s69, v24
  v_xor_b32 v25, 0, v24
  ds_read_b128 v[128:131], v25
  v_xor_b32 v25, 32, v24
  ds_read_b128 v[132:135], v25
  v_xor_b32 v25, 64, v24
  ds_read_b128 v[136:139], v25
  v_xor_b32 v25, 96, v24
  ds_read_b128 v[140:143], v25
  v_xor_b32 v25, 128, v24
  ds_read_b128 v[144:147], v25
  v_xor_b32 v25, 160, v24
  ds_read_b128 v[148:151], v25
  v_xor_b32 v25, 192, v24
  ds_read_b128 v[152:155], v25
  v_xor_b32 v25, 224, v24
  ds_read_b128 v[156:159], v25
  s_waitcnt lgkmcnt(0)
  v_mov_b32 v64, 0
  v_mov_b32 v65, 0
  v_mov_b32 v66, 0
  v_mov_b32 v67, 0
  v_mov_b32 v68, 0
  v_mov_b32 v69, 0
  v_mov_b32 v70, 0
  v_mov_b32 v71, 0
  v_mov_b32 v72, 0
  v_mov_b32 v73, 0
  v_mov_b32 v74, 0
  v_mov_b32 v75, 0
  v_mov_b32 v76, 0
  v_mov_b32 v77, 0
  v_mov_b32 v78, 0
  v_mov_b32 v79, 0
  v_mov_b32 v80, 0
  v_mov_b32 v81, 0
  v_mov_b32 v82, 0
  v_mov_b32 v83, 0
  v_mov_b32 v84, 0
  v_mov_b32 v85, 0
  v_mov_b32 v86, 0
  v_mov_b32 v87, 0
  v_mov_b32 v88, 0
  v_mov_b32 v89, 0
  v_mov_b32 v90, 0
  v_mov_b32 v91, 0
  v_mov_b32 v92, 0
  v_mov_b32 v93, 0
  v_mov_b32 v94, 0
  v_mov_b32 v95, 0
  v_mov_b32 v96, 0
  v_mov_b32 v97, 0
  v_mov_b32 v98, 0
  v_mov_b32 v99, 0
  v_mov_b32 v100, 0
  v_mov_b32 v101, 0
  v_mov_b32 v102, 0
  v_mov_b32 v103, 0
  v_mov_b32 v104, 0
  v_mov_b32 v105, 0
  v_mov_b32 v106, 0
  v_mov_b32 v107, 0
  v_mov_b32 v108, 0
  v_mov_b32 v109, 0
  v_mov_b32 v110, 0
  v_mov_b32 v111, 0
  v_mov_b32 v112, 0
  v_mov_b32 v113, 0
  v_mov_b32 v114, 0
  v_mov_b32 v115, 0
  v_mov_b32 v116, 0
  v_mov_b32 v117, 0
  v_mov_b32 v118, 0
  v_mov_b32 v119, 0
  v_mov_b32 v120, 0
  v_mov_b32 v121, 0
  v_mov_b32 v122, 0
  v_mov_b32 v123, 0
  v_mov_b32 v124, 0
  v_mov_b32 v125, 0
  v_mov_b32 v126, 0
  v_mov_b32 v127, 0
  v_mov_b32 v248, 0xf149f2ca
  v_mov_b32 v249, 0
  s_mov_b32 s53, 0
  s_and_b32 s60, s2, 1
  s_lshr_b32 s52, s2, 1
  s_and_b32 s52, s52, 3
  s_lshr_b32 s59, s2, 3
  s_lshr_b32 s61, s59, 1
  s_and_b32 s59, s59, 1
  s_lshl_b32 s52, s52, 1
  s_add_u32 s62, s52, s59
  s_lshl_b32 s62, s62, 6
  s_xor_b32 s52, s60, 1
  s_mul_i32 s52, s52, 8
  s_xor_b32 s61, s61, s52
  s_lshl_b32 s59, s59, 3
  s_add_u32 s65, s61, s59
  s_lshl_b32 s66, s3, 12
  s_add_u32 s66, s66, 131072
  s_mov_b32 s67, 0
  s_lshl_b32 s63, s3, 19
  s_lshl_b32 s52, s62, 1
  s_add_u32 s63, s63, s52
  s_lshl_b32 s64, s60, 4
  s_add_u32 s64, s64, s61
  s_lshl_b32 s64, s64, 7
  s_lshl_b32 s52, s3, 4
  s_add_u32 s64, s64, s52
  s_lshl_b32 s64, s64, 10
  s_cmp_eq_u32 s60, 0
  s_cselect_b32 s40, s70, s76
  s_cselect_b32 s41, s71, s77
  s_and_b32 s41, s41, 0xffff
  s_mov_b32 s42, 4194304
  s_mov_b32 s43, 0x20000
  s_mov_b32 s36, s8
  s_and_b32 s37, s9, 0xffff
  s_mov_b32 s38, 524288
  s_mov_b32 s39, 0x20000
  s_xor_b32 s52, s4, 1
  s_lshl_b32 s52, s52, 3
  s_mul_i32 s59, s4, 4
  s_xor_b32 s59, s6, s59
  s_add_u32 s52, s52, s59
  s_lshl_b32 s52, s52, 8
  s_lshl_b32 s59, s7, 2
  s_add_u32 s52, s52, s59
  s_add_u32 s52, s52, s5
  s_lshl_b32 s78, s52, 10
  v_lshrrev_b32 v16, 3, v0
  v_lshlrev_b32 v16, 10, v16
  v_and_b32 v17, 7, v0
  v_lshrrev_b32 v18, 4, v0
  v_lshlrev_b32 v19, 1, v18
  v_xor_b32 v17, v17, v19
  v_lshl_add_u32 v14, v17, 4, v16
  v_and_b32 v19, 15, v0
  v_lshrrev_b32 v20, 1, v18
  v_lshlrev_b32 v20, 4, v20
  v_and_b32 v21, 1, v18
  v_lshl_add_u32 v20, v21, 2, v20
  v_lshrrev_b32 v22, 2, v19
  v_add_u32 v20, v20, v22
  v_lshlrev_b32 v20, 7, v20
  v_lshrrev_b32 v22, 3, v19
  v_lshl_add_u32 v22, v21, 1, v22
  v_lshl_add_u32 v20, v22, 5, v20
  v_and_b32 v22, 3, v19
  v_lshl_add_u32 v15, v22, 3, v20
  s_lshr_b32 s17, s2, 3
  s_lshl_b32 s17, s17, 3
  s_add_u32 s17, s17, s3
  s_lshl_b32 s17, s17, 14
  s_lshr_b32 s18, s57, 1
  s_lshl_b32 s18, s18, 8
  s_add_u32 s17, s17, s18
  v_lshrrev_b32 v255, 1, v0
  v_lshlrev_b32 v255, 10, v255
  v_and_b32 v17, 1, v0
  v_lshl_add_u32 v255, v17, 7, v255
  s_mov_b32 s52, s4
  s_cmp_eq_u32 s52, 0
  s_cbranch_scc0 RP_skip
  s_setprio 1
RP_skip:
K1_LOOP:
  s_waitcnt vmcnt(8)
  ds_read_b128 v[160:163], v7
  v_xor_b32 v13, 32, v7
  ds_read_b128 v[164:167], v13
  v_xor_b32 v12, 64, v7
  ds_read_b128 v[168:171], v12
  v_xor_b32 v13, 96, v7
  ds_read_b128 v[172:175], v13
  v_xor_b32 v12, 128, v7
  ds_read_b128 v[176:179], v12
  v_xor_b32 v13, 160, v7
  ds_read_b128 v[180:183], v13
  v_xor_b32 v12, 192, v7
  ds_read_b128 v[184:187], v12
  v_xor_b32 v13, 224, v7
  ds_read_b128 v[188:191], v13
  s_waitcnt lgkmcnt(0)
  s_cmp_eq_u32 s4, 0
  s_cbranch_scc1 DMAB_4
  s_mov_b32 m0, s48
  s_add_u32 s52, s50, 4096
  buffer_load_dwordx4 v2, s[28:31], s50 offen offset:0 sc0 lds
  buffer_load_dwordx4 v3, s[28:31], s50 offen offset:1024 sc0 lds
  buffer_load_dwordx4 v4, s[28:31], s50 offen offset:2048 sc0 lds
  buffer_load_dwordx4 v5, s[28:31], s50 offen offset:3072 sc0 lds
  s_add_u32 m0, s48, 4096
  s_add_u32 s50, s50, 32768
  buffer_load_dwordx4 v2, s[28:31], s52 offen offset:0 sc0 lds
  buffer_load_dwordx4 v3, s[28:31], s52 offen offset:1024 sc0 lds
  buffer_load_dwordx4 v4, s[28:31], s52 offen offset:2048 sc0 lds
  buffer_load_dwordx4 v5, s[28:31], s52 offen offset:3072 sc0 lds
  s_branch DMAE_4
DMAB_4:
  s_mov_b32 m0, s48
  s_add_u32 s52, s50, 4096
  buffer_load_dwordx4 v2, s[28:31], s50 offen offset:0 nt lds
  buffer_load_dwordx4 v3, s[28:31], s50 offen offset:1024 nt lds
  buffer_load_dwordx4 v4, s[28:31], s50 offen offset:2048 nt lds
  buffer_load_dwordx4 v5, s[28:31], s50 offen offset:3072 nt lds
  s_add_u32 m0, s48, 4096
  s_add_u32 s50, s50, 32768
  buffer_load_dwordx4 v2, s[28:31], s52 offen offset:0 nt lds
  buffer_load_dwordx4 v3, s[28:31], s52 offen offset:1024 nt lds
  buffer_load_dwordx4 v4, s[28:31], s52 offen offset:2048 nt lds
  buffer_load_dwordx4 v5, s[28:31], s52 offen offset:3072 nt lds
DMAE_4:
  v_mfma_f32_32x32x16_bf16 v[224:239], v[160:163], v[128:131], 0
  v_mfma_f32_32x32x16_bf16 v[224:239], v[164:167], v[132:135], v[224:239]
  v_mfma_f32_32x32x16_bf16 v[224:239], v[168:171], v[136:139], v[224:239]
  v_mfma_f32_32x32x16_bf16 v[224:239], v[172:175], v[140:143], v[224:239]
  v_mfma_f32_32x32x16_bf16 v[224:239], v[176:179], v[144:147], v[224:239]
  v_mfma_f32_32x32x16_bf16 v[224:239], v[180:183], v[148:151], v[224:239]
  v_mfma_f32_32x32x16_bf16 v[224:239], v[184:187], v[152:155], v[224:239]
  v_mfma_f32_32x32x16_bf16 v[224:239], v[188:191], v[156:159], v[224:239]
  s_waitcnt vmcnt(8)
  ds_read_b64_tr_b16 v[192:193], v8 offset:0
  ds_read_b64_tr_b16 v[194:195], v8 offset:1024
  ds_read_b64_tr_b16 v[196:197], v8 offset:4096
  ds_read_b64_tr_b16 v[198:199], v8 offset:5120
  ds_read_b64_tr_b16 v[200:201], v9 offset:0
  ds_read_b64_tr_b16 v[202:203], v9 offset:1024
  ds_read_b64_tr_b16 v[204:205], v9 offset:4096
  ds_read_b64_tr_b16 v[206:207], v9 offset:5120
  ds_read_b64_tr_b16 v[208:209], v10 offset:0
  ds_read_b64_tr_b16 v[210:211], v10 offset:1024
  ds_read_b64_tr_b16 v[212:213], v10 offset:4096
  ds_read_b64_tr_b16 v[214:215], v10 offset:5120
  ds_read_b64_tr_b16 v[216:217], v11 offset:0
  ds_read_b64_tr_b16 v[218:219], v11 offset:1024
  ds_read_b64_tr_b16 v[220:221], v11 offset:4096
  ds_read_b64_tr_b16 v[222:223], v11 offset:5120
  s_nop 7
  v_max3_f32 v252, v224, v225, v226
  v_max3_f32 v252, v252, v227, v228
  v_max3_f32 v252, v252, v229, v230
  v_max3_f32 v252, v252, v231, v232
  v_max3_f32 v252, v252, v233, v234
  v_max3_f32 v252, v252, v235, v236
  v_max3_f32 v252, v252, v237, v238
  v_max_f32 v252, v252, v239
  v_mov_b32 v253, v252
  s_nop 1
  v_permlane32_swap_b32 v253, v252
  v_max_f32 v252, v252, v253
  v_max_f32 v254, v248, v252
  v_sub_f32 v250, v248, v254
  v_mul_f32 v250, s54, v250
  v_exp_f32 v250, v250
  v_mul_f32 v251, s54, v254
  v_mov_b32 v248, v254
  v_fma_f32 v224, v224, s54, -v251
  v_fma_f32 v225, v225, s54, -v251
  v_fma_f32 v226, v226, s54, -v251
  v_fma_f32 v227, v227, s54, -v251
  v_fma_f32 v228, v228, s54, -v251
  v_fma_f32 v229, v229, s54, -v251
  v_fma_f32 v230, v230, s54, -v251
  v_fma_f32 v231, v231, s54, -v251
  v_fma_f32 v232, v232, s54, -v251
  v_fma_f32 v233, v233, s54, -v251
  v_fma_f32 v234, v234, s54, -v251
  v_fma_f32 v235, v235, s54, -v251
  v_fma_f32 v236, v236, s54, -v251
  v_fma_f32 v237, v237, s54, -v251
  v_fma_f32 v238, v238, s54, -v251
  v_fma_f32 v239, v239, s54, -v251
  v_exp_f32 v224, v224
  v_exp_f32 v225, v225
  v_exp_f32 v226, v226
  v_exp_f32 v227, v227
  v_exp_f32 v228, v228
  v_exp_f32 v229, v229
  v_exp_f32 v230, v230
  v_exp_f32 v231, v231
  v_exp_f32 v232, v232
  v_exp_f32 v233, v233
  v_exp_f32 v234, v234
  v_exp_f32 v235, v235
  v_exp_f32 v236, v236
  v_exp_f32 v237, v237
  v_exp_f32 v238, v238
  v_exp_f32 v239, v239
  v_mul_f32 v249, v249, v250
  v_mul_f32 v64, v64, v250
  v_mul_f32 v65, v65, v250
  v_mul_f32 v66, v66, v250
  v_mul_f32 v67, v67, v250
  v_mul_f32 v68, v68, v250
  v_mul_f32 v69, v69, v250
  v_mul_f32 v70, v70, v250
  v_mul_f32 v71, v71, v250
  v_mul_f32 v72, v72, v250
  v_mul_f32 v73, v73, v250
  v_mul_f32 v74, v74, v250
  v_mul_f32 v75, v75, v250
  v_mul_f32 v76, v76, v250
  v_mul_f32 v77, v77, v250
  v_mul_f32 v78, v78, v250
  v_mul_f32 v79, v79, v250
  v_mul_f32 v80, v80, v250
  v_mul_f32 v81, v81, v250
  v_mul_f32 v82, v82, v250
  v_mul_f32 v83, v83, v250
  v_mul_f32 v84, v84, v250
  v_mul_f32 v85, v85, v250
  v_mul_f32 v86, v86, v250
  v_mul_f32 v87, v87, v250
  v_mul_f32 v88, v88, v250
  v_mul_f32 v89, v89, v250
  v_mul_f32 v90, v90, v250
  v_mul_f32 v91, v91, v250
  v_mul_f32 v92, v92, v250
  v_mul_f32 v93, v93, v250
  v_mul_f32 v94, v94, v250
  v_mul_f32 v95, v95, v250
  v_mul_f32 v96, v96, v250
  v_mul_f32 v97, v97, v250
  v_mul_f32 v98, v98, v250
  v_mul_f32 v99, v99, v250
  v_mul_f32 v100, v100, v250
  v_mul_f32 v101, v101, v250
  v_mul_f32 v102, v102, v250
  v_mul_f32 v103, v103, v250
  v_mul_f32 v104, v104, v250
  v_mul_f32 v105, v105, v250
  v_mul_f32 v106, v106, v250
  v_mul_f32 v107, v107, v250
  v_mul_f32 v108, v108, v250
  v_mul_f32 v109, v109, v250
  v_mul_f32 v110, v110, v250
  v_mul_f32 v111, v111, v250
  v_mul_f32 v112, v112, v250
  v_mul_f32 v113, v113, v250
  v_mul_f32 v114, v114, v250
  v_mul_f32 v115, v115, v250
  v_mul_f32 v116, v116, v250
  v_mul_f32 v117, v117, v250
  v_mul_f32 v118, v118, v250
  v_mul_f32 v119, v119, v250
  v_mul_f32 v120, v120, v250
  v_mul_f32 v121, v121, v250
  v_mul_f32 v122, v122, v250
  v_mul_f32 v123, v123, v250
  v_mul_f32 v124, v124, v250
  v_mul_f32 v125, v125, v250
  v_mul_f32 v126, v126, v250
  v_mul_f32 v127, v127, v250
  v_add_f32 v249, v249, v224
  v_add_f32 v249, v249, v225
  v_add_f32 v249, v249, v226
  v_add_f32 v249, v249, v227
  v_add_f32 v249, v249, v228
  v_add_f32 v249, v249, v229
  v_add_f32 v249, v249, v230
  v_add_f32 v249, v249, v231
  v_add_f32 v249, v249, v232
  v_add_f32 v249, v249, v233
  v_add_f32 v249, v249, v234
  v_add_f32 v249, v249, v235
  v_add_f32 v249, v249, v236
  v_add_f32 v249, v249, v237
  v_add_f32 v249, v249, v238
  v_add_f32 v249, v249, v239
  v_cvt_pk_bf16_f32 v240, v224, v225
  v_cvt_pk_bf16_f32 v241, v226, v227
  v_cvt_pk_bf16_f32 v242, v228, v229
  v_cvt_pk_bf16_f32 v243, v230, v231
  v_cvt_pk_bf16_f32 v244, v232, v233
  v_cvt_pk_bf16_f32 v245, v234, v235
  v_cvt_pk_bf16_f32 v246, v236, v237
  v_cvt_pk_bf16_f32 v247, v238, v239
  s_waitcnt lgkmcnt(0)
  s_cmp_eq_u32 s4, 0
  s_cbranch_scc1 DMAB_5
  s_mov_b32 m0, s49
  s_add_u32 s52, s51, 4096
  buffer_load_dwordx4 v6, s[32:35], s51 offen offset:0 sc0 lds
  buffer_load_dwordx4 v6, s[32:35], s51 offen offset:1024 sc0 lds
  buffer_load_dwordx4 v6, s[32:35], s51 offen offset:2048 sc0 lds
  buffer_load_dwordx4 v6, s[32:35], s51 offen offset:3072 sc0 lds
  s_add_u32 m0, s49, 4096
  s_add_u32 s51, s51, 32768
  buffer_load_dwordx4 v6, s[32:35], s52 offen offset:0 sc0 lds
  buffer_load_dwordx4 v6, s[32:35], s52 offen offset:1024 sc0 lds
  buffer_load_dwordx4 v6, s[32:35], s52 offen offset:2048 sc0 lds
  buffer_load_dwordx4 v6, s[32:35], s52 offen offset:3072 sc0 lds
  s_branch DMAE_5
DMAB_5:
  s_mov_b32 m0, s49
  s_add_u32 s52, s51, 4096
  buffer_load_dwordx4 v6, s[32:35], s51 offen offset:0 nt lds
  buffer_load_dwordx4 v6, s[32:35], s51 offen offset:1024 nt lds
  buffer_load_dwordx4 v6, s[32:35], s51 offen offset:2048 nt lds
  buffer_load_dwordx4 v6, s[32:35], s51 offen offset:3072 nt lds
  s_add_u32 m0, s49, 4096
  s_add_u32 s51, s51, 32768
  buffer_load_dwordx4 v6, s[32:35], s52 offen offset:0 nt lds
  buffer_load_dwordx4 v6, s[32:35], s52 offen offset:1024 nt lds
  buffer_load_dwordx4 v6, s[32:35], s52 offen offset:2048 nt lds
  buffer_load_dwordx4 v6, s[32:35], s52 offen offset:3072 nt lds
DMAE_5:
  v_mfma_f32_32x32x16_bf16 v[64:79], v[192:195], v[240:243], v[64:79]
  v_mfma_f32_32x32x16_bf16 v[80:95], v[200:203], v[240:243], v[80:95]
  v_mfma_f32_32x32x16_bf16 v[96:111], v[208:211], v[240:243], v[96:111]
  v_mfma_f32_32x32x16_bf16 v[112:127], v[216:219], v[240:243], v[112:127]
  v_mfma_f32_32x32x16_bf16 v[64:79], v[196:199], v[244:247], v[64:79]
  v_mfma_f32_32x32x16_bf16 v[80:95], v[204:207], v[244:247], v[80:95]
  v_mfma_f32_32x32x16_bf16 v[96:111], v[212:215], v[244:247], v[96:111]
  v_mfma_f32_32x32x16_bf16 v[112:127], v[220:223], v[244:247], v[112:127]
  s_barrier
  s_add_u32 s53, s53, 1
  s_cmp_lt_u32 s53, 15
  s_cbranch_scc1 K1_LOOP
  v_add_u32 v2, s48, v15
  v_xor_b32 v3, 32, v2
  v_xor_b32 v4, 64, v2
  v_xor_b32 v5, 96, v2
  s_lshr_b32 s18, s57, 1
  s_cmp_eq_u32 s18, 1
  s_mov_b32 s18, 0xaaaaaaaa
  s_cselect_b32 exec_lo, s18, 1
  s_mov_b32 exec_hi, 0
  buffer_load_dword v63, v255, s[40:43], s17 offen
  s_mov_b64 exec, -1
  s_waitcnt vmcnt(9)
  ds_read_b128 v[160:163], v7
  v_xor_b32 v13, 32, v7
  ds_read_b128 v[164:167], v13
  v_xor_b32 v12, 64, v7
  ds_read_b128 v[168:171], v12
  v_xor_b32 v13, 96, v7
  ds_read_b128 v[172:175], v13
  v_xor_b32 v12, 128, v7
  ds_read_b128 v[176:179], v12
  v_xor_b32 v13, 160, v7
  ds_read_b128 v[180:183], v13
  v_xor_b32 v12, 192, v7
  ds_read_b128 v[184:187], v12
  v_xor_b32 v13, 224, v7
  ds_read_b128 v[188:191], v13
  s_waitcnt lgkmcnt(0)
  v_mfma_f32_32x32x16_bf16 v[224:239], v[160:163], v[128:131], 0
  v_mfma_f32_32x32x16_bf16 v[224:239], v[164:167], v[132:135], v[224:239]
  v_mfma_f32_32x32x16_bf16 v[224:239], v[168:171], v[136:139], v[224:239]
  v_mfma_f32_32x32x16_bf16 v[224:239], v[172:175], v[140:143], v[224:239]
  v_mfma_f32_32x32x16_bf16 v[224:239], v[176:179], v[144:147], v[224:239]
  v_mfma_f32_32x32x16_bf16 v[224:239], v[180:183], v[148:151], v[224:239]
  v_mfma_f32_32x32x16_bf16 v[224:239], v[184:187], v[152:155], v[224:239]
  v_mfma_f32_32x32x16_bf16 v[224:239], v[188:191], v[156:159], v[224:239]
  s_waitcnt vmcnt(1)
  ds_read_b64_tr_b16 v[192:193], v8 offset:0
  ds_read_b64_tr_b16 v[194:195], v8 offset:1024
  ds_read_b64_tr_b16 v[196:197], v8 offset:4096
  ds_read_b64_tr_b16 v[198:199], v8 offset:5120
  ds_read_b64_tr_b16 v[200:201], v9 offset:0
  ds_read_b64_tr_b16 v[202:203], v9 offset:1024
  ds_read_b64_tr_b16 v[204:205], v9 offset:4096
  ds_read_b64_tr_b16 v[206:207], v9 offset:5120
  ds_read_b64_tr_b16 v[208:209], v10 offset:0
  ds_read_b64_tr_b16 v[210:211], v10 offset:1024
  ds_read_b64_tr_b16 v[212:213], v10 offset:4096
  ds_read_b64_tr_b16 v[214:215], v10 offset:5120
  ds_read_b64_tr_b16 v[216:217], v11 offset:0
  ds_read_b64_tr_b16 v[218:219], v11 offset:1024
  ds_read_b64_tr_b16 v[220:221], v11 offset:4096
  ds_read_b64_tr_b16 v[222:223], v11 offset:5120
  s_nop 7
  v_max3_f32 v252, v224, v225, v226
  v_max3_f32 v252, v252, v227, v228
  v_max3_f32 v252, v252, v229, v230
  v_max3_f32 v252, v252, v231, v232
  v_max3_f32 v252, v252, v233, v234
  v_max3_f32 v252, v252, v235, v236
  v_max3_f32 v252, v252, v237, v238
  v_max_f32 v252, v252, v239
  v_mov_b32 v253, v252
  s_nop 1
  v_permlane32_swap_b32 v253, v252
  v_max_f32 v252, v252, v253
  v_max_f32 v254, v248, v252
  v_sub_f32 v250, v248, v254
  v_mul_f32 v250, s54, v250
  v_exp_f32 v250, v250
  v_mul_f32 v251, s54, v254
  v_mov_b32 v248, v254
  v_fma_f32 v224, v224, s54, -v251
  v_fma_f32 v225, v225, s54, -v251
  v_fma_f32 v226, v226, s54, -v251
  v_fma_f32 v227, v227, s54, -v251
  v_fma_f32 v228, v228, s54, -v251
  v_fma_f32 v229, v229, s54, -v251
  v_fma_f32 v230, v230, s54, -v251
  v_fma_f32 v231, v231, s54, -v251
  v_fma_f32 v232, v232, s54, -v251
  v_fma_f32 v233, v233, s54, -v251
  v_fma_f32 v234, v234, s54, -v251
  v_fma_f32 v235, v235, s54, -v251
  v_fma_f32 v236, v236, s54, -v251
  v_fma_f32 v237, v237, s54, -v251
  v_fma_f32 v238, v238, s54, -v251
  v_fma_f32 v239, v239, s54, -v251
  v_exp_f32 v224, v224
  v_exp_f32 v225, v225
  v_exp_f32 v226, v226
  v_exp_f32 v227, v227
  v_exp_f32 v228, v228
  v_exp_f32 v229, v229
  v_exp_f32 v230, v230
  v_exp_f32 v231, v231
  v_exp_f32 v232, v232
  v_exp_f32 v233, v233
  v_exp_f32 v234, v234
  v_exp_f32 v235, v235
  v_exp_f32 v236, v236
  v_exp_f32 v237, v237
  v_exp_f32 v238, v238
  v_exp_f32 v239, v239
  v_mul_f32 v249, v249, v250
  v_mul_f32 v64, v64, v250
  v_mul_f32 v65, v65, v250
  v_mul_f32 v66, v66, v250
  v_mul_f32 v67, v67, v250
  v_mul_f32 v68, v68, v250
  v_mul_f32 v69, v69, v250
  v_mul_f32 v70, v70, v250
  v_mul_f32 v71, v71, v250
  v_mul_f32 v72, v72, v250
  v_mul_f32 v73, v73, v250
  v_mul_f32 v74, v74, v250
  v_mul_f32 v75, v75, v250
  v_mul_f32 v76, v76, v250
  v_mul_f32 v77, v77, v250
  v_mul_f32 v78, v78, v250
  v_mul_f32 v79, v79, v250
  v_mul_f32 v80, v80, v250
  v_mul_f32 v81, v81, v250
  v_mul_f32 v82, v82, v250
  v_mul_f32 v83, v83, v250
  v_mul_f32 v84, v84, v250
  v_mul_f32 v85, v85, v250
  v_mul_f32 v86, v86, v250
  v_mul_f32 v87, v87, v250
  v_mul_f32 v88, v88, v250
  v_mul_f32 v89, v89, v250
  v_mul_f32 v90, v90, v250
  v_mul_f32 v91, v91, v250
  v_mul_f32 v92, v92, v250
  v_mul_f32 v93, v93, v250
  v_mul_f32 v94, v94, v250
  v_mul_f32 v95, v95, v250
  v_mul_f32 v96, v96, v250
  v_mul_f32 v97, v97, v250
  v_mul_f32 v98, v98, v250
  v_mul_f32 v99, v99, v250
  v_mul_f32 v100, v100, v250
  v_mul_f32 v101, v101, v250
  v_mul_f32 v102, v102, v250
  v_mul_f32 v103, v103, v250
  v_mul_f32 v104, v104, v250
  v_mul_f32 v105, v105, v250
  v_mul_f32 v106, v106, v250
  v_mul_f32 v107, v107, v250
  v_mul_f32 v108, v108, v250
  v_mul_f32 v109, v109, v250
  v_mul_f32 v110, v110, v250
  v_mul_f32 v111, v111, v250
  v_mul_f32 v112, v112, v250
  v_mul_f32 v113, v113, v250
  v_mul_f32 v114, v114, v250
  v_mul_f32 v115, v115, v250
  v_mul_f32 v116, v116, v250
  v_mul_f32 v117, v117, v250
  v_mul_f32 v118, v118, v250
  v_mul_f32 v119, v119, v250
  v_mul_f32 v120, v120, v250
  v_mul_f32 v121, v121, v250
  v_mul_f32 v122, v122, v250
  v_mul_f32 v123, v123, v250
  v_mul_f32 v124, v124, v250
  v_mul_f32 v125, v125, v250
  v_mul_f32 v126, v126, v250
  v_mul_f32 v127, v127, v250
  v_add_f32 v249, v249, v224
  v_add_f32 v249, v249, v225
  v_add_f32 v249, v249, v226
  v_add_f32 v249, v249, v227
  v_add_f32 v249, v249, v228
  v_add_f32 v249, v249, v229
  v_add_f32 v249, v249, v230
  v_add_f32 v249, v249, v231
  v_add_f32 v249, v249, v232
  v_add_f32 v249, v249, v233
  v_add_f32 v249, v249, v234
  v_add_f32 v249, v249, v235
  v_add_f32 v249, v249, v236
  v_add_f32 v249, v249, v237
  v_add_f32 v249, v249, v238
  v_add_f32 v249, v249, v239
  v_cvt_pk_bf16_f32 v240, v224, v225
  v_cvt_pk_bf16_f32 v241, v226, v227
  v_cvt_pk_bf16_f32 v242, v228, v229
  v_cvt_pk_bf16_f32 v243, v230, v231
  v_cvt_pk_bf16_f32 v244, v232, v233
  v_cvt_pk_bf16_f32 v245, v234, v235
  v_cvt_pk_bf16_f32 v246, v236, v237
  v_cvt_pk_bf16_f32 v247, v238, v239
  s_waitcnt lgkmcnt(0)
  s_nop 1
  v_mfma_f32_32x32x16_bf16 v[64:79], v[192:195], v[240:243], v[64:79]
  v_mfma_f32_32x32x16_bf16 v[80:95], v[200:203], v[240:243], v[80:95]
  v_mfma_f32_32x32x16_bf16 v[96:111], v[208:211], v[240:243], v[96:111]
  v_mfma_f32_32x32x16_bf16 v[112:127], v[216:219], v[240:243], v[112:127]
  v_mfma_f32_32x32x16_bf16 v[64:79], v[196:199], v[244:247], v[64:79]
  v_mfma_f32_32x32x16_bf16 v[80:95], v[204:207], v[244:247], v[80:95]
  v_mfma_f32_32x32x16_bf16 v[96:111], v[212:215], v[244:247], v[96:111]
  v_mfma_f32_32x32x16_bf16 v[112:127], v[220:223], v[244:247], v[112:127]
  v_mov_b32 v253, v249
  v_lshlrev_b32 v6, 4, v0
  v_lshlrev_b32 v8, 3, v0
  v_permlane32_swap_b32 v253, v249
  v_add_u32 v7, s48, v6
  v_add_u32 v9, s66, v8
  v_add_f32 v251, v249, v253
  v_mov_b32 v250, v248
  s_waitcnt lgkmcnt(0)
  ds_write_b64 v9, v[250:251]
  s_nop 3
  ds_write_b128 v7, v[96:99] offset:8192
  ds_write_b128 v7, v[100:103] offset:9216
  ds_write_b128 v7, v[104:107] offset:10240
  ds_write_b128 v7, v[108:111] offset:11264
  ds_write_b128 v7, v[112:115] offset:12288
  ds_write_b128 v7, v[116:119] offset:13312
  ds_write_b128 v7, v[120:123] offset:14336
  ds_write_b128 v7, v[124:127] offset:15360
  ds_write_b128 v7, v[80:83] offset:0
  ds_write_b128 v7, v[84:87] offset:1024
  ds_write_b128 v7, v[88:91] offset:2048
  ds_write_b128 v7, v[92:95] offset:3072
  s_add_u32 s52, s5, 1
  s_and_b32 s52, s52, 3
  s_lshl_b32 s59, s4, 2
  s_add_u32 s52, s52, s59
  s_lshl_b32 s59, s52, 14
  v_add_u32 v10, s59, v6
  s_lshl_b32 s52, s52, 12
  s_add_u32 s52, s52, 131072
  v_add_u32 v252, s52, v8
  s_add_u32 s52, s5, 2
  s_and_b32 s52, s52, 3
  s_lshl_b32 s59, s4, 2
  s_add_u32 s52, s52, s59
  s_lshl_b32 s59, s52, 14
  v_add_u32 v11, s59, v6
  s_lshl_b32 s52, s52, 12
  s_add_u32 s52, s52, 131072
  v_add_u32 v253, s52, v8
  s_add_u32 s52, s5, 3
  s_and_b32 s52, s52, 3
  s_lshl_b32 s59, s4, 2
  s_add_u32 s52, s52, s59
  s_lshl_b32 s59, s52, 14
  v_add_u32 v12, s59, v6
  s_lshl_b32 s52, s52, 12
  s_add_u32 s52, s52, 131072
  v_add_u32 v254, s52, v8
  v_and_b32 v1, 16, v0
  v_lshlrev_b32 v1, 13, v1
  v_lshrrev_b32 v13, 5, v0
  v_lshl_add_u32 v1, v13, 8, v1
  v_and_b32 v13, 15, v0
  v_lshl_add_u32 v1, v13, 4, v1
  s_waitcnt lgkmcnt(0)
  s_barrier
  ds_read_b64 v[240:241], v252
  ds_read_b64 v[242:243], v253
  ds_read_b64 v[244:245], v254
  ds_read_b128 v[80:83], v10 offset:12288
  ds_read_b128 v[84:87], v10 offset:13312
  ds_read_b128 v[88:91], v10 offset:14336
  ds_read_b128 v[92:95], v10 offset:15360
  ds_read_b128 v[96:99], v11 offset:8192
  ds_read_b128 v[100:103], v11 offset:9216
  ds_read_b128 v[104:107], v11 offset:10240
  ds_read_b128 v[108:111], v11 offset:11264
  ds_read_b128 v[112:115], v12 offset:0
  ds_read_b128 v[116:119], v12 offset:1024
  ds_read_b128 v[120:123], v12 offset:2048
  ds_read_b128 v[124:127], v12 offset:3072
  s_waitcnt lgkmcnt(12)
  v_max3_f32 v246, v248, v240, v242
  v_max_f32 v246, v246, v244
  v_sub_f32 v247, v248, v246
  v_sub_f32 v252, v240, v246
  v_sub_f32 v253, v242, v246
  v_sub_f32 v254, v244, v246
  v_mul_f32 v247, s54, v247
  v_mul_f32 v252, s54, v252
  v_mul_f32 v253, s54, v253
  v_mul_f32 v254, s54, v254
  v_exp_f32 v247, v247
  v_exp_f32 v252, v252
  v_exp_f32 v253, v253
  v_exp_f32 v254, v254
  s_nop 0
  v_mul_f32 v255, v247, v251
  v_fma_f32 v255, v252, v241, v255
  v_fma_f32 v255, v253, v243, v255
  v_fma_f32 v255, v254, v245, v255
  v_rcp_f32 v255, v255
  s_nop 0
  v_mul_f32 v247, v247, v255
  v_mul_f32 v252, v252, v255
  v_mul_f32 v253, v253, v255
  v_mul_f32 v254, v254, v255
  v_mul_f32 v64, v64, v247
  v_mul_f32 v65, v65, v247
  v_mul_f32 v66, v66, v247
  v_mul_f32 v67, v67, v247
  v_mul_f32 v68, v68, v247
  v_mul_f32 v69, v69, v247
  v_mul_f32 v70, v70, v247
  v_mul_f32 v71, v71, v247
  v_mul_f32 v72, v72, v247
  v_mul_f32 v73, v73, v247
  v_mul_f32 v74, v74, v247
  v_mul_f32 v75, v75, v247
  v_mul_f32 v76, v76, v247
  v_mul_f32 v77, v77, v247
  v_mul_f32 v78, v78, v247
  v_mul_f32 v79, v79, v247
  s_waitcnt lgkmcnt(0)
  v_fma_f32 v64, v80, v252, v64
  v_fma_f32 v65, v81, v252, v65
  v_fma_f32 v66, v82, v252, v66
  v_fma_f32 v67, v83, v252, v67
  v_fma_f32 v68, v84, v252, v68
  v_fma_f32 v69, v85, v252, v69
  v_fma_f32 v70, v86, v252, v70
  v_fma_f32 v71, v87, v252, v71
  v_fma_f32 v72, v88, v252, v72
  v_fma_f32 v73, v89, v252, v73
  v_fma_f32 v74, v90, v252, v74
  v_fma_f32 v75, v91, v252, v75
  v_fma_f32 v76, v92, v252, v76
  v_fma_f32 v77, v93, v252, v77
  v_fma_f32 v78, v94, v252, v78
  v_fma_f32 v79, v95, v252, v79
  v_fma_f32 v64, v96, v253, v64
  v_fma_f32 v65, v97, v253, v65
  v_fma_f32 v66, v98, v253, v66
  v_fma_f32 v67, v99, v253, v67
  v_fma_f32 v68, v100, v253, v68
  v_fma_f32 v69, v101, v253, v69
  v_fma_f32 v70, v102, v253, v70
  v_fma_f32 v71, v103, v253, v71
  v_fma_f32 v72, v104, v253, v72
  v_fma_f32 v73, v105, v253, v73
  v_fma_f32 v74, v106, v253, v74
  v_fma_f32 v75, v107, v253, v75
  v_fma_f32 v76, v108, v253, v76
  v_fma_f32 v77, v109, v253, v77
  v_fma_f32 v78, v110, v253, v78
  v_fma_f32 v79, v111, v253, v79
  v_fma_f32 v64, v112, v254, v64
  v_fma_f32 v65, v113, v254, v65
  v_fma_f32 v66, v114, v254, v66
  v_fma_f32 v67, v115, v254, v67
  v_fma_f32 v68, v116, v254, v68
  v_fma_f32 v69, v117, v254, v69
  v_fma_f32 v70, v118, v254, v70
  v_fma_f32 v71, v119, v254, v71
  v_fma_f32 v72, v120, v254, v72
  v_fma_f32 v73, v121, v254, v73
  v_fma_f32 v74, v122, v254, v74
  v_fma_f32 v75, v123, v254, v75
  v_fma_f32 v76, v124, v254, v76
  v_fma_f32 v77, v125, v254, v77
  v_fma_f32 v78, v126, v254, v78
  v_fma_f32 v79, v127, v254, v79
  v_cvt_pk_bf16_f32 v240, v64, v65
  v_cvt_pk_bf16_f32 v241, v66, v67
  v_cvt_pk_bf16_f32 v242, v68, v69
  v_cvt_pk_bf16_f32 v243, v70, v71
  v_cvt_pk_bf16_f32 v244, v72, v73
  v_cvt_pk_bf16_f32 v245, v74, v75
  v_cvt_pk_bf16_f32 v246, v76, v77
  v_cvt_pk_bf16_f32 v247, v78, v79
  buffer_store_dwordx4 v[240:243], v1, s[44:47], s78 offen sc1
  buffer_store_dwordx4 v[244:247], v1, s[44:47], s78 offen offset:512 sc1
  s_barrier
  v_add_u32 v8, s66, v6
  v_add_u32 v10, s66, v15
  v_xor_b32 v11, 32, v10
  v_xor_b32 v12, 64, v10
  v_xor_b32 v13, 96, v10
  s_waitcnt lgkmcnt(0)
  s_add_u32 m0, s48, 0
  s_add_u32 s52, s65, 0
  s_and_b32 s52, s52, 15
  s_lshl_b32 s59, s52, 15
  s_add_u32 s59, s59, s63
  buffer_load_dwordx4 v14, s[40:43], s59 offen  lds
  s_add_u32 m0, s48, 1024
  s_add_u32 s59, s59, 8192
  buffer_load_dwordx4 v14, s[40:43], s59 offen  lds
  s_add_u32 m0, s48, 2048
  s_add_u32 s59, s59, 8192
  buffer_load_dwordx4 v14, s[40:43], s59 offen  lds
  s_add_u32 m0, s48, 3072
  s_add_u32 s59, s59, 8192
  buffer_load_dwordx4 v14, s[40:43], s59 offen  lds
  s_waitcnt vmcnt(4)
  s_barrier
  s_cmp_lg_u32 s3, 0
  s_cbranch_scc1 F_NOSIG
  s_mov_b64 exec, 1
  s_lshl_b32 s52, s6, 5
  v_mov_b32 v9, s52
  v_mov_b32 v1, 1
  global_atomic_add v9, v1, s[10:11] sc1
  s_mov_b64 exec, -1
F_NOSIG:
  s_add_u32 m0, s48, 8192
  s_add_u32 s52, s65, 1
  s_and_b32 s52, s52, 15
  s_lshl_b32 s59, s52, 15
  s_add_u32 s59, s59, s63
  buffer_load_dwordx4 v14, s[40:43], s59 offen  lds
  s_add_u32 m0, s48, 9216
  s_add_u32 s59, s59, 8192
  buffer_load_dwordx4 v14, s[40:43], s59 offen  lds
  s_add_u32 m0, s48, 10240
  s_add_u32 s59, s59, 8192
  buffer_load_dwordx4 v14, s[40:43], s59 offen  lds
  s_add_u32 m0, s48, 11264
  s_add_u32 s59, s59, 8192
  buffer_load_dwordx4 v14, s[40:43], s59 offen  lds
  s_add_u32 m0, s48, 12288
  s_add_u32 s52, s65, 2
  s_and_b32 s52, s52, 15
  s_lshl_b32 s59, s52, 15
  s_add_u32 s59, s59, s63
  buffer_load_dwordx4 v14, s[40:43], s59 offen  lds
  s_add_u32 m0, s48, 13312
  s_add_u32 s59, s59, 8192
  buffer_load_dwordx4 v14, s[40:43], s59 offen  lds
  s_add_u32 m0, s48, 14336
  s_add_u32 s59, s59, 8192
  buffer_load_dwordx4 v14, s[40:43], s59 offen  lds
  s_add_u32 m0, s48, 15360
  s_add_u32 s59, s59, 8192
  buffer_load_dwordx4 v14, s[40:43], s59 offen  lds
  s_add_u32 m0, s66, 0
  s_add_u32 s52, s65, 3
  s_and_b32 s52, s52, 15
  s_lshl_b32 s59, s52, 15
  s_add_u32 s59, s59, s63
  buffer_load_dwordx4 v14, s[40:43], s59 offen  lds
  s_add_u32 m0, s66, 1024
  s_add_u32 s59, s59, 8192
  buffer_load_dwordx4 v14, s[40:43], s59 offen  lds
  s_add_u32 m0, s66, 2048
  s_add_u32 s59, s59, 8192
  buffer_load_dwordx4 v14, s[40:43], s59 offen  lds
  s_add_u32 m0, s66, 3072
  s_add_u32 s59, s59, 8192
  buffer_load_dwordx4 v14, s[40:43], s59 offen  lds
  s_add_u32 m0, s48, 4096
  s_add_u32 s52, s65, 4
  s_and_b32 s52, s52, 15
  s_lshl_b32 s59, s52, 15
  s_add_u32 s59, s59, s63
  buffer_load_dwordx4 v14, s[40:43], s59 offen  lds
  s_add_u32 m0, s48, 5120
  s_add_u32 s59, s59, 8192
  buffer_load_dwordx4 v14, s[40:43], s59 offen  lds
  s_add_u32 m0, s48, 6144
  s_add_u32 s59, s59, 8192
  buffer_load_dwordx4 v14, s[40:43], s59 offen  lds
  s_add_u32 m0, s48, 7168
  s_add_u32 s59, s59, 8192
  buffer_load_dwordx4 v14, s[40:43], s59 offen  lds
  s_waitcnt vmcnt(16)
  ds_read_b64_tr_b16 v[128:129], v2 offset:0
  ds_read_b64_tr_b16 v[130:131], v2 offset:1024
  ds_read_b64_tr_b16 v[132:133], v3 offset:0
  ds_read_b64_tr_b16 v[134:135], v3 offset:1024
  ds_read_b64_tr_b16 v[136:137], v4 offset:0
  ds_read_b64_tr_b16 v[138:139], v4 offset:1024
  ds_read_b64_tr_b16 v[140:141], v5 offset:0
  ds_read_b64_tr_b16 v[142:143], v5 offset:1024
  s_waitcnt lgkmcnt(0)
  s_add_u32 m0, s48, 0
  s_add_u32 s52, s65, 5
  s_and_b32 s52, s52, 15
  s_lshl_b32 s59, s52, 15
  s_add_u32 s59, s59, s63
  buffer_load_dwordx4 v14, s[40:43], s59 offen  lds
  s_add_u32 m0, s48, 1024
  s_add_u32 s59, s59, 8192
  buffer_load_dwordx4 v14, s[40:43], s59 offen  lds
  s_add_u32 m0, s48, 2048
  s_add_u32 s59, s59, 8192
  buffer_load_dwordx4 v14, s[40:43], s59 offen  lds
  s_add_u32 m0, s48, 3072
  s_add_u32 s59, s59, 8192
  buffer_load_dwordx4 v14, s[40:43], s59 offen  lds
  s_waitcnt vmcnt(16)
  ds_read_b64_tr_b16 v[144:145], v2 offset:8192
  ds_read_b64_tr_b16 v[146:147], v2 offset:9216
  ds_read_b64_tr_b16 v[148:149], v3 offset:8192
  ds_read_b64_tr_b16 v[150:151], v3 offset:9216
  ds_read_b64_tr_b16 v[152:153], v4 offset:8192
  ds_read_b64_tr_b16 v[154:155], v4 offset:9216
  ds_read_b64_tr_b16 v[156:157], v5 offset:8192
  ds_read_b64_tr_b16 v[158:159], v5 offset:9216
  s_waitcnt lgkmcnt(0)
  s_add_u32 m0, s48, 8192
  s_add_u32 s52, s65, 6
  s_and_b32 s52, s52, 15
  s_lshl_b32 s59, s52, 15
  s_add_u32 s59, s59, s63
  buffer_load_dwordx4 v14, s[40:43], s59 offen  lds
  s_add_u32 m0, s48, 9216
  s_add_u32 s59, s59, 8192
  buffer_load_dwordx4 v14, s[40:43], s59 offen  lds
  s_add_u32 m0, s48, 10240
  s_add_u32 s59, s59, 8192
  buffer_load_dwordx4 v14, s[40:43], s59 offen  lds
  s_add_u32 m0, s48, 11264
  s_add_u32 s59, s59, 8192
  buffer_load_dwordx4 v14, s[40:43], s59 offen  lds
  s_waitcnt vmcnt(16)
  ds_read_b64_tr_b16 v[160:161], v2 offset:12288
  ds_read_b64_tr_b16 v[162:163], v2 offset:13312
  ds_read_b64_tr_b16 v[164:165], v3 offset:12288
  ds_read_b64_tr_b16 v[166:167], v3 offset:13312
  ds_read_b64_tr_b16 v[168:169], v4 offset:12288
  ds_read_b64_tr_b16 v[170:171], v4 offset:13312
  ds_read_b64_tr_b16 v[172:173], v5 offset:12288
  ds_read_b64_tr_b16 v[174:175], v5 offset:13312
  s_waitcnt lgkmcnt(0)
  s_add_u32 m0, s48, 12288
  s_add_u32 s52, s65, 7
  s_and_b32 s52, s52, 15
  s_lshl_b32 s59, s52, 15
  s_add_u32 s59, s59, s63
  buffer_load_dwordx4 v14, s[40:43], s59 offen  lds
  s_add_u32 m0, s48, 13312
  s_add_u32 s59, s59, 8192
  buffer_load_dwordx4 v14, s[40:43], s59 offen  lds
  s_add_u32 m0, s48, 14336
  s_add_u32 s59, s59, 8192
  buffer_load_dwordx4 v14, s[40:43], s59 offen  lds
  s_add_u32 m0, s48, 15360
  s_add_u32 s59, s59, 8192
  buffer_load_dwordx4 v14, s[40:43], s59 offen  lds
  s_waitcnt vmcnt(16)
  ds_read_b64_tr_b16 v[176:177], v10 offset:0
  ds_read_b64_tr_b16 v[178:179], v10 offset:1024
  ds_read_b64_tr_b16 v[180:181], v11 offset:0
  ds_read_b64_tr_b16 v[182:183], v11 offset:1024
  ds_read_b64_tr_b16 v[184:185], v12 offset:0
  ds_read_b64_tr_b16 v[186:187], v12 offset:1024
  ds_read_b64_tr_b16 v[188:189], v13 offset:0
  ds_read_b64_tr_b16 v[190:191], v13 offset:1024
  s_waitcnt lgkmcnt(0)
  s_add_u32 m0, s66, 0
  s_add_u32 s52, s65, 8
  s_and_b32 s52, s52, 15
  s_lshl_b32 s59, s52, 15
  s_add_u32 s59, s59, s63
  buffer_load_dwordx4 v14, s[40:43], s59 offen  lds
  s_add_u32 m0, s66, 1024
  s_add_u32 s59, s59, 8192
  buffer_load_dwordx4 v14, s[40:43], s59 offen  lds
  s_add_u32 m0, s66, 2048
  s_add_u32 s59, s59, 8192
  buffer_load_dwordx4 v14, s[40:43], s59 offen  lds
  s_add_u32 m0, s66, 3072
  s_add_u32 s59, s59, 8192
  buffer_load_dwordx4 v14, s[40:43], s59 offen  lds
  s_waitcnt vmcnt(16)
  ds_read_b64_tr_b16 v[16:17], v2 offset:4096
  ds_read_b64_tr_b16 v[18:19], v2 offset:5120
  ds_read_b64_tr_b16 v[20:21], v3 offset:4096
  ds_read_b64_tr_b16 v[22:23], v3 offset:5120
  ds_read_b64_tr_b16 v[24:25], v4 offset:4096
  ds_read_b64_tr_b16 v[26:27], v4 offset:5120
  ds_read_b64_tr_b16 v[28:29], v5 offset:4096
  ds_read_b64_tr_b16 v[30:31], v5 offset:5120
  s_waitcnt lgkmcnt(0)
  s_add_u32 m0, s48, 4096
  s_add_u32 s52, s65, 9
  s_and_b32 s52, s52, 15
  s_lshl_b32 s59, s52, 15
  s_add_u32 s59, s59, s63
  buffer_load_dwordx4 v14, s[40:43], s59 offen  lds
  s_add_u32 m0, s48, 5120
  s_add_u32 s59, s59, 8192
  buffer_load_dwordx4 v14, s[40:43], s59 offen  lds
  s_add_u32 m0, s48, 6144
  s_add_u32 s59, s59, 8192
  buffer_load_dwordx4 v14, s[40:43], s59 offen  lds
  s_add_u32 m0, s48, 7168
  s_add_u32 s59, s59, 8192
  buffer_load_dwordx4 v14, s[40:43], s59 offen  lds
  s_waitcnt vmcnt(16)
  ds_read_b64_tr_b16 v[32:33], v2 offset:0
  ds_read_b64_tr_b16 v[34:35], v2 offset:1024
  ds_read_b64_tr_b16 v[36:37], v3 offset:0
  ds_read_b64_tr_b16 v[38:39], v3 offset:1024
  ds_read_b64_tr_b16 v[40:41], v4 offset:0
  ds_read_b64_tr_b16 v[42:43], v4 offset:1024
  ds_read_b64_tr_b16 v[44:45], v5 offset:0
  ds_read_b64_tr_b16 v[46:47], v5 offset:1024
  s_waitcnt lgkmcnt(0)
  s_add_u32 m0, s48, 0
  s_add_u32 s52, s65, 10
  s_and_b32 s52, s52, 15
  s_lshl_b32 s59, s52, 15
  s_add_u32 s59, s59, s63
  buffer_load_dwordx4 v14, s[40:43], s59 offen  lds
  s_add_u32 m0, s48, 1024
  s_add_u32 s59, s59, 8192
  buffer_load_dwordx4 v14, s[40:43], s59 offen  lds
  s_add_u32 m0, s48, 2048
  s_add_u32 s59, s59, 8192
  buffer_load_dwordx4 v14, s[40:43], s59 offen  lds
  s_add_u32 m0, s48, 3072
  s_add_u32 s59, s59, 8192
  buffer_load_dwordx4 v14, s[40:43], s59 offen  lds
  s_waitcnt vmcnt(16)
  ds_read_b64_tr_b16 v[48:49], v2 offset:8192
  ds_read_b64_tr_b16 v[50:51], v2 offset:9216
  ds_read_b64_tr_b16 v[52:53], v3 offset:8192
  ds_read_b64_tr_b16 v[54:55], v3 offset:9216
  ds_read_b64_tr_b16 v[56:57], v4 offset:8192
  ds_read_b64_tr_b16 v[58:59], v4 offset:9216
  ds_read_b64_tr_b16 v[60:61], v5 offset:8192
  ds_read_b64_tr_b16 v[62:63], v5 offset:9216
  s_waitcnt lgkmcnt(0)
  s_add_u32 m0, s48, 8192
  s_add_u32 s52, s65, 11
  s_and_b32 s52, s52, 15
  s_lshl_b32 s59, s52, 15
  s_add_u32 s59, s59, s63
  buffer_load_dwordx4 v14, s[40:43], s59 offen  lds
  s_add_u32 m0, s48, 9216
  s_add_u32 s59, s59, 8192
  buffer_load_dwordx4 v14, s[40:43], s59 offen  lds
  s_add_u32 m0, s48, 10240
  s_add_u32 s59, s59, 8192
  buffer_load_dwordx4 v14, s[40:43], s59 offen  lds
  s_add_u32 m0, s48, 11264
  s_add_u32 s59, s59, 8192
  buffer_load_dwordx4 v14, s[40:43], s59 offen  lds
  s_waitcnt vmcnt(16)
  ds_read_b64_tr_b16 v[224:225], v2 offset:12288
  ds_read_b64_tr_b16 v[226:227], v2 offset:13312
  ds_read_b64_tr_b16 v[228:229], v3 offset:12288
  ds_read_b64_tr_b16 v[230:231], v3 offset:13312
  ds_read_b64_tr_b16 v[232:233], v4 offset:12288
  ds_read_b64_tr_b16 v[234:235], v4 offset:13312
  ds_read_b64_tr_b16 v[236:237], v5 offset:12288
  ds_read_b64_tr_b16 v[238:239], v5 offset:13312
  s_waitcnt lgkmcnt(0)
  s_add_u32 m0, s48, 12288
  s_add_u32 s52, s65, 12
  s_and_b32 s52, s52, 15
  s_lshl_b32 s59, s52, 15
  s_add_u32 s59, s59, s63
  buffer_load_dwordx4 v14, s[40:43], s59 offen  lds
  s_add_u32 m0, s48, 13312
  s_add_u32 s59, s59, 8192
  buffer_load_dwordx4 v14, s[40:43], s59 offen  lds
  s_add_u32 m0, s48, 14336
  s_add_u32 s59, s59, 8192
  buffer_load_dwordx4 v14, s[40:43], s59 offen  lds
  s_add_u32 m0, s48, 15360
  s_add_u32 s59, s59, 8192
  buffer_load_dwordx4 v14, s[40:43], s59 offen  lds
  s_cmp_lg_u32 s3, 0
  s_cbranch_scc1 F_NOEP
  s_mov_b64 exec, 1
  global_load_dword v1, v9, s[10:11] sc1
  s_mov_b64 exec, -1
F_NOEP:
  s_waitcnt vmcnt(16)
  ds_read_b64_tr_b16 v[192:193], v10 offset:0
  ds_read_b64_tr_b16 v[194:195], v10 offset:1024
  ds_read_b64_tr_b16 v[196:197], v11 offset:0
  ds_read_b64_tr_b16 v[198:199], v11 offset:1024
  ds_read_b64_tr_b16 v[200:201], v12 offset:0
  ds_read_b64_tr_b16 v[202:203], v12 offset:1024
  ds_read_b64_tr_b16 v[204:205], v13 offset:0
  ds_read_b64_tr_b16 v[206:207], v13 offset:1024
  s_waitcnt lgkmcnt(0)
  s_add_u32 m0, s66, 0
  s_add_u32 s52, s65, 13
  s_and_b32 s52, s52, 15
  s_lshl_b32 s59, s52, 15
  s_add_u32 s59, s59, s63
  buffer_load_dwordx4 v14, s[40:43], s59 offen  lds
  s_add_u32 m0, s66, 1024
  s_add_u32 s59, s59, 8192
  buffer_load_dwordx4 v14, s[40:43], s59 offen  lds
  s_add_u32 m0, s66, 2048
  s_add_u32 s59, s59, 8192
  buffer_load_dwordx4 v14, s[40:43], s59 offen  lds
  s_add_u32 m0, s66, 3072
  s_add_u32 s59, s59, 8192
  buffer_load_dwordx4 v14, s[40:43], s59 offen  lds
  s_waitcnt vmcnt(16)
  ds_read_b64_tr_b16 v[208:209], v2 offset:4096
  ds_read_b64_tr_b16 v[210:211], v2 offset:5120
  ds_read_b64_tr_b16 v[212:213], v3 offset:4096
  ds_read_b64_tr_b16 v[214:215], v3 offset:5120
  ds_read_b64_tr_b16 v[216:217], v4 offset:4096
  ds_read_b64_tr_b16 v[218:219], v4 offset:5120
  ds_read_b64_tr_b16 v[220:221], v5 offset:4096
  ds_read_b64_tr_b16 v[222:223], v5 offset:5120
  s_waitcnt lgkmcnt(0)
  s_add_u32 m0, s48, 4096
  s_add_u32 s52, s65, 14
  s_and_b32 s52, s52, 15
  s_lshl_b32 s59, s52, 15
  s_add_u32 s59, s59, s63
  buffer_load_dwordx4 v14, s[40:43], s59 offen  lds
  s_add_u32 m0, s48, 5120
  s_add_u32 s59, s59, 8192
  buffer_load_dwordx4 v14, s[40:43], s59 offen  lds
  s_add_u32 m0, s48, 6144
  s_add_u32 s59, s59, 8192
  buffer_load_dwordx4 v14, s[40:43], s59 offen  lds
  s_add_u32 m0, s48, 7168
  s_add_u32 s59, s59, 8192
  buffer_load_dwordx4 v14, s[40:43], s59 offen  lds
  s_waitcnt vmcnt(16)
  ds_read_b64_tr_b16 v[96:97], v2 offset:0
  ds_read_b64_tr_b16 v[98:99], v2 offset:1024
  ds_read_b64_tr_b16 v[100:101], v3 offset:0
  ds_read_b64_tr_b16 v[102:103], v3 offset:1024
  ds_read_b64_tr_b16 v[104:105], v4 offset:0
  ds_read_b64_tr_b16 v[106:107], v4 offset:1024
  ds_read_b64_tr_b16 v[108:109], v5 offset:0
  ds_read_b64_tr_b16 v[110:111], v5 offset:1024
  s_waitcnt lgkmcnt(0)
  s_add_u32 m0, s48, 0
  s_add_u32 s52, s65, 15
  s_and_b32 s52, s52, 15
  s_lshl_b32 s59, s52, 15
  s_add_u32 s59, s59, s63
  buffer_load_dwordx4 v14, s[40:43], s59 offen  lds
  s_add_u32 m0, s48, 1024
  s_add_u32 s59, s59, 8192
  buffer_load_dwordx4 v14, s[40:43], s59 offen  lds
  s_add_u32 m0, s48, 2048
  s_add_u32 s59, s59, 8192
  buffer_load_dwordx4 v14, s[40:43], s59 offen  lds
  s_add_u32 m0, s48, 3072
  s_add_u32 s59, s59, 8192
  buffer_load_dwordx4 v14, s[40:43], s59 offen  lds
  s_waitcnt vmcnt(16)
  ds_read_b64_tr_b16 v[112:113], v2 offset:8192
  ds_read_b64_tr_b16 v[114:115], v2 offset:9216
  ds_read_b64_tr_b16 v[116:117], v3 offset:8192
  ds_read_b64_tr_b16 v[118:119], v3 offset:9216
  ds_read_b64_tr_b16 v[120:121], v4 offset:8192
  ds_read_b64_tr_b16 v[122:123], v4 offset:9216
  ds_read_b64_tr_b16 v[124:125], v5 offset:8192
  ds_read_b64_tr_b16 v[126:127], v5 offset:9216
  s_cmp_lg_u32 s3, 0
  s_cbranch_scc1 F_WAIT
  s_mov_b64 exec, 1
  s_mov_b32 s59, 0
  s_waitcnt vmcnt(12)
  v_readfirstlane_b32 s52, v1
  s_cmp_ge_u32 s52, 32
  s_cbranch_scc1 F_GOT
F_POLL:
  global_load_dword v1, v9, s[10:11] sc1
  s_waitcnt vmcnt(0)
  v_readfirstlane_b32 s52, v1
  s_add_u32 s59, s59, 1
  s_cmp_ge_u32 s52, 32
  s_cbranch_scc1 F_GOT
  s_sleep 2
  s_cmp_lt_u32 s59, 0x100000
  s_cbranch_scc1 F_POLL
F_GOT:
  s_mov_b64 exec, -1
F_WAIT:
  s_barrier
  s_add_u32 s52, s65, 0
  s_and_b32 s52, s52, 15
  s_lshl_b32 s52, s52, 10
  s_add_u32 s52, s52, s64
  buffer_load_dwordx4 v[64:67], v6, s[44:47], s52 offen sc1
  s_add_u32 s52, s65, 1
  s_and_b32 s52, s52, 15
  s_lshl_b32 s52, s52, 10
  s_add_u32 s52, s52, s64
  buffer_load_dwordx4 v[68:71], v6, s[44:47], s52 offen sc1
  s_add_u32 s52, s65, 2
  s_and_b32 s52, s52, 15
  s_lshl_b32 s52, s52, 10
  s_add_u32 s52, s52, s64
  buffer_load_dwordx4 v[72:75], v6, s[44:47], s52 offen sc1
  s_add_u32 s52, s65, 3
  s_and_b32 s52, s52, 15
  s_lshl_b32 s52, s52, 10
  s_add_u32 s52, s52, s64
  buffer_load_dwordx4 v[76:79], v6, s[44:47], s52 offen sc1
  s_add_u32 s52, s65, 4
  s_and_b32 s52, s52, 15
  s_lshl_b32 s52, s52, 10
  s_add_u32 s52, s52, s64
  buffer_load_dwordx4 v[80:83], v6, s[44:47], s52 offen sc1
  s_add_u32 s52, s65, 5
  s_and_b32 s52, s52, 15
  s_lshl_b32 s52, s52, 10
  s_add_u32 s52, s52, s64
  buffer_load_dwordx4 v[84:87], v6, s[44:47], s52 offen sc1
  s_add_u32 s52, s65, 6
  s_and_b32 s52, s52, 15
  s_lshl_b32 s52, s52, 10
  s_add_u32 s52, s52, s64
  buffer_load_dwordx4 v[88:91], v6, s[44:47], s52 offen sc1
  s_add_u32 s52, s65, 7
  s_and_b32 s52, s52, 15
  s_lshl_b32 s52, s52, 10
  s_add_u32 s52, s52, s64
  buffer_load_dwordx4 v[92:95], v6, s[44:47], s52 offen sc1
  s_waitcnt vmcnt(7) lgkmcnt(0)
  v_mfma_f32_16x16x32_bf16 v[240:243], v[128:131], v[64:67], 0
  v_mfma_f32_16x16x32_bf16 v[244:247], v[132:135], v[64:67], 0
  v_mfma_f32_16x16x32_bf16 v[248:251], v[136:139], v[64:67], 0
  v_mfma_f32_16x16x32_bf16 v[252:255], v[140:143], v[64:67], 0
  s_add_u32 s52, s65, 8
  s_and_b32 s52, s52, 15
  s_lshl_b32 s52, s52, 10
  s_add_u32 s52, s52, s64
  buffer_load_dwordx4 v[64:67], v6, s[44:47], s52 offen sc1
  s_waitcnt vmcnt(7)
  v_mfma_f32_16x16x32_bf16 v[240:243], v[144:147], v[68:71], v[240:243]
  v_mfma_f32_16x16x32_bf16 v[244:247], v[148:151], v[68:71], v[244:247]
  v_mfma_f32_16x16x32_bf16 v[248:251], v[152:155], v[68:71], v[248:251]
  v_mfma_f32_16x16x32_bf16 v[252:255], v[156:159], v[68:71], v[252:255]
  s_add_u32 s52, s65, 9
  s_and_b32 s52, s52, 15
  s_lshl_b32 s52, s52, 10
  s_add_u32 s52, s52, s64
  buffer_load_dwordx4 v[68:71], v6, s[44:47], s52 offen sc1
  ds_read_b64_tr_b16 v[128:129], v2 offset:12288
  ds_read_b64_tr_b16 v[130:131], v2 offset:13312
  ds_read_b64_tr_b16 v[132:133], v3 offset:12288
  ds_read_b64_tr_b16 v[134:135], v3 offset:13312
  ds_read_b64_tr_b16 v[136:137], v4 offset:12288
  ds_read_b64_tr_b16 v[138:139], v4 offset:13312
  ds_read_b64_tr_b16 v[140:141], v5 offset:12288
  ds_read_b64_tr_b16 v[142:143], v5 offset:13312
  s_waitcnt vmcnt(7)
  v_mfma_f32_16x16x32_bf16 v[240:243], v[160:163], v[72:75], v[240:243]
  v_mfma_f32_16x16x32_bf16 v[244:247], v[164:167], v[72:75], v[244:247]
  v_mfma_f32_16x16x32_bf16 v[248:251], v[168:171], v[72:75], v[248:251]
  v_mfma_f32_16x16x32_bf16 v[252:255], v[172:175], v[72:75], v[252:255]
  s_add_u32 s52, s65, 10
  s_and_b32 s52, s52, 15
  s_lshl_b32 s52, s52, 10
  s_add_u32 s52, s52, s64
  buffer_load_dwordx4 v[72:75], v6, s[44:47], s52 offen sc1
  ds_read_b64_tr_b16 v[144:145], v10 offset:0
  ds_read_b64_tr_b16 v[146:147], v10 offset:1024
  ds_read_b64_tr_b16 v[148:149], v11 offset:0
  ds_read_b64_tr_b16 v[150:151], v11 offset:1024
  ds_read_b64_tr_b16 v[152:153], v12 offset:0
  ds_read_b64_tr_b16 v[154:155], v12 offset:1024
  ds_read_b64_tr_b16 v[156:157], v13 offset:0
  ds_read_b64_tr_b16 v[158:159], v13 offset:1024
  s_waitcnt vmcnt(7)
  v_mfma_f32_16x16x32_bf16 v[240:243], v[176:179], v[76:79], v[240:243]
  v_mfma_f32_16x16x32_bf16 v[244:247], v[180:183], v[76:79], v[244:247]
  v_mfma_f32_16x16x32_bf16 v[248:251], v[184:187], v[76:79], v[248:251]
  v_mfma_f32_16x16x32_bf16 v[252:255], v[188:191], v[76:79], v[252:255]
  s_add_u32 s52, s65, 11
  s_and_b32 s52, s52, 15
  s_lshl_b32 s52, s52, 10
  s_add_u32 s52, s52, s64
  buffer_load_dwordx4 v[76:79], v6, s[44:47], s52 offen sc1
  ds_read_b64_tr_b16 v[160:161], v2 offset:4096
  ds_read_b64_tr_b16 v[162:163], v2 offset:5120
  ds_read_b64_tr_b16 v[164:165], v3 offset:4096
  ds_read_b64_tr_b16 v[166:167], v3 offset:5120
  ds_read_b64_tr_b16 v[168:169], v4 offset:4096
  ds_read_b64_tr_b16 v[170:171], v4 offset:5120
  ds_read_b64_tr_b16 v[172:173], v5 offset:4096
  ds_read_b64_tr_b16 v[174:175], v5 offset:5120
  s_waitcnt vmcnt(7)
  v_mfma_f32_16x16x32_bf16 v[240:243], v[16:19], v[80:83], v[240:243]
  v_mfma_f32_16x16x32_bf16 v[244:247], v[20:23], v[80:83], v[244:247]
  v_mfma_f32_16x16x32_bf16 v[248:251], v[24:27], v[80:83], v[248:251]
  v_mfma_f32_16x16x32_bf16 v[252:255], v[28:31], v[80:83], v[252:255]
  s_add_u32 s52, s65, 12
  s_and_b32 s52, s52, 15
  s_lshl_b32 s52, s52, 10
  s_add_u32 s52, s52, s64
  buffer_load_dwordx4 v[80:83], v6, s[44:47], s52 offen sc1
  ds_read_b64_tr_b16 v[176:177], v2 offset:0
  ds_read_b64_tr_b16 v[178:179], v2 offset:1024
  ds_read_b64_tr_b16 v[180:181], v3 offset:0
  ds_read_b64_tr_b16 v[182:183], v3 offset:1024
  ds_read_b64_tr_b16 v[184:185], v4 offset:0
  ds_read_b64_tr_b16 v[186:187], v4 offset:1024
  ds_read_b64_tr_b16 v[188:189], v5 offset:0
  ds_read_b64_tr_b16 v[190:191], v5 offset:1024
  s_waitcnt vmcnt(7)
  v_mfma_f32_16x16x32_bf16 v[240:243], v[32:35], v[84:87], v[240:243]
  v_mfma_f32_16x16x32_bf16 v[244:247], v[36:39], v[84:87], v[244:247]
  v_mfma_f32_16x16x32_bf16 v[248:251], v[40:43], v[84:87], v[248:251]
  v_mfma_f32_16x16x32_bf16 v[252:255], v[44:47], v[84:87], v[252:255]
  s_add_u32 s52, s65, 13
  s_and_b32 s52, s52, 15
  s_lshl_b32 s52, s52, 10
  s_add_u32 s52, s52, s64
  buffer_load_dwordx4 v[84:87], v6, s[44:47], s52 offen sc1
  s_waitcnt vmcnt(7)
  v_mfma_f32_16x16x32_bf16 v[240:243], v[48:51], v[88:91], v[240:243]
  v_mfma_f32_16x16x32_bf16 v[244:247], v[52:55], v[88:91], v[244:247]
  v_mfma_f32_16x16x32_bf16 v[248:251], v[56:59], v[88:91], v[248:251]
  v_mfma_f32_16x16x32_bf16 v[252:255], v[60:63], v[88:91], v[252:255]
  s_add_u32 s52, s65, 14
  s_and_b32 s52, s52, 15
  s_lshl_b32 s52, s52, 10
  s_add_u32 s52, s52, s64
  buffer_load_dwordx4 v[88:91], v6, s[44:47], s52 offen sc1
  s_waitcnt vmcnt(7)
  v_mfma_f32_16x16x32_bf16 v[240:243], v[224:227], v[92:95], v[240:243]
  v_mfma_f32_16x16x32_bf16 v[244:247], v[228:231], v[92:95], v[244:247]
  v_mfma_f32_16x16x32_bf16 v[248:251], v[232:235], v[92:95], v[248:251]
  v_mfma_f32_16x16x32_bf16 v[252:255], v[236:239], v[92:95], v[252:255]
  s_add_u32 s52, s65, 15
  s_and_b32 s52, s52, 15
  s_lshl_b32 s52, s52, 10
  s_add_u32 s52, s52, s64
  buffer_load_dwordx4 v[92:95], v6, s[44:47], s52 offen sc1
  s_waitcnt vmcnt(7)
  v_mfma_f32_16x16x32_bf16 v[240:243], v[192:195], v[64:67], v[240:243]
  v_mfma_f32_16x16x32_bf16 v[244:247], v[196:199], v[64:67], v[244:247]
  v_mfma_f32_16x16x32_bf16 v[248:251], v[200:203], v[64:67], v[248:251]
  v_mfma_f32_16x16x32_bf16 v[252:255], v[204:207], v[64:67], v[252:255]
  s_waitcnt vmcnt(6)
  v_mfma_f32_16x16x32_bf16 v[240:243], v[208:211], v[68:71], v[240:243]
  v_mfma_f32_16x16x32_bf16 v[244:247], v[212:215], v[68:71], v[244:247]
  v_mfma_f32_16x16x32_bf16 v[248:251], v[216:219], v[68:71], v[248:251]
  v_mfma_f32_16x16x32_bf16 v[252:255], v[220:223], v[68:71], v[252:255]
  s_waitcnt vmcnt(5)
  v_mfma_f32_16x16x32_bf16 v[240:243], v[96:99], v[72:75], v[240:243]
  v_mfma_f32_16x16x32_bf16 v[244:247], v[100:103], v[72:75], v[244:247]
  v_mfma_f32_16x16x32_bf16 v[248:251], v[104:107], v[72:75], v[248:251]
  v_mfma_f32_16x16x32_bf16 v[252:255], v[108:111], v[72:75], v[252:255]
  s_waitcnt vmcnt(4)
  v_mfma_f32_16x16x32_bf16 v[240:243], v[112:115], v[76:79], v[240:243]
  v_mfma_f32_16x16x32_bf16 v[244:247], v[116:119], v[76:79], v[244:247]
  v_mfma_f32_16x16x32_bf16 v[248:251], v[120:123], v[76:79], v[248:251]
  v_mfma_f32_16x16x32_bf16 v[252:255], v[124:127], v[76:79], v[252:255]
  s_waitcnt vmcnt(3) lgkmcnt(0)
  v_mfma_f32_16x16x32_bf16 v[240:243], v[128:131], v[80:83], v[240:243]
  v_mfma_f32_16x16x32_bf16 v[244:247], v[132:135], v[80:83], v[244:247]
  v_mfma_f32_16x16x32_bf16 v[248:251], v[136:139], v[80:83], v[248:251]
  v_mfma_f32_16x16x32_bf16 v[252:255], v[140:143], v[80:83], v[252:255]
  s_waitcnt vmcnt(2)
  v_mfma_f32_16x16x32_bf16 v[240:243], v[144:147], v[84:87], v[240:243]
  v_mfma_f32_16x16x32_bf16 v[244:247], v[148:151], v[84:87], v[244:247]
  v_mfma_f32_16x16x32_bf16 v[248:251], v[152:155], v[84:87], v[248:251]
  v_mfma_f32_16x16x32_bf16 v[252:255], v[156:159], v[84:87], v[252:255]
  s_waitcnt vmcnt(1)
  v_mfma_f32_16x16x32_bf16 v[240:243], v[160:163], v[88:91], v[240:243]
  v_mfma_f32_16x16x32_bf16 v[244:247], v[164:167], v[88:91], v[244:247]
  v_mfma_f32_16x16x32_bf16 v[248:251], v[168:171], v[88:91], v[248:251]
  v_mfma_f32_16x16x32_bf16 v[252:255], v[172:175], v[88:91], v[252:255]
  s_waitcnt vmcnt(0)
  v_mfma_f32_16x16x32_bf16 v[240:243], v[176:179], v[92:95], v[240:243]
  v_mfma_f32_16x16x32_bf16 v[244:247], v[180:183], v[92:95], v[244:247]
  v_mfma_f32_16x16x32_bf16 v[248:251], v[184:187], v[92:95], v[248:251]
  v_mfma_f32_16x16x32_bf16 v[252:255], v[188:191], v[92:95], v[252:255]
  v_and_b32 v10, 15, v0
  v_lshrrev_b32 v11, 4, v0
  v_and_b32 v12, 7, v10
  v_xor_b32 v12, v12, v11
  v_lshlrev_b32 v12, 4, v12
  v_lshl_add_u32 v12, v10, 8, v12
  v_add_u32 v12, s48, v12
  s_nop 7
  s_nop 3
  v_xor_b32 v13, 0, v12
  ds_write_b128 v13, v[240:243]
  v_xor_b32 v13, 64, v12
  ds_write_b128 v13, v[244:247]
  v_xor_b32 v13, 128, v12
  ds_write_b128 v13, v[248:251]
  v_xor_b32 v13, 192, v12
  ds_write_b128 v13, v[252:255]
  s_waitcnt lgkmcnt(0)
  s_barrier
  s_lshl_b32 s52, s3, 1
  v_lshrrev_b32 v10, 5, v0
  v_add_u32 v10, s52, v10
  v_and_b32 v11, 31, v0
  v_lshrrev_b32 v12, 1, v11
  v_and_b32 v13, 7, v10
  v_xor_b32 v12, v12, v13
  v_lshlrev_b32 v12, 4, v12
  v_and_b32 v13, 1, v11
  v_lshl_add_u32 v12, v13, 3, v12
  v_lshl_add_u32 v12, v10, 8, v12
  ds_read_b64 v[16:17], v12 offset:0
  ds_read_b64 v[18:19], v12 offset:16384
  ds_read_b64 v[20:21], v12 offset:32768
  ds_read_b64 v[22:23], v12 offset:49152
  v_add_u32 v12, 65536, v12
  ds_read_b64 v[24:25], v12 offset:0
  ds_read_b64 v[26:27], v12 offset:16384
  ds_read_b64 v[28:29], v12 offset:32768
  ds_read_b64 v[30:31], v12 offset:49152
  s_waitcnt lgkmcnt(0)
  v_add_f32 v16, v16, v18
  v_add_f32 v17, v17, v19
  v_add_f32 v20, v20, v22
  v_add_f32 v21, v21, v23
  v_add_f32 v24, v24, v26
  v_add_f32 v25, v25, v27
  v_add_f32 v28, v28, v30
  v_add_f32 v29, v29, v31
  v_add_f32 v16, v16, v20
  v_add_f32 v17, v17, v21
  v_add_f32 v24, v24, v28
  v_add_f32 v25, v25, v29
  v_add_f32 v16, v16, v24
  v_add_f32 v17, v17, v25
  v_cvt_pk_bf16_f32 v16, v16, v17
  s_lshl_b32 s52, s61, 15
  s_lshl_b32 s59, s60, 10
  s_add_u32 s52, s52, s59
  s_lshl_b32 s59, s62, 1
  s_add_u32 s52, s52, s59
  v_lshlrev_b32 v12, 11, v10
  v_lshl_add_u32 v12, v11, 2, v12
  buffer_store_dword v16, v12, s[36:39], s52 offen
K1_END:
  s_endpgm
.section .rodata,"a"
.p2align 6
.amdhsa_kernel concat_heads__gqa_block_cached__mha_block_cached__near_ridge_kernel
  .amdhsa_next_free_vgpr 256
  .amdhsa_next_free_sgpr 80
  .amdhsa_accum_offset 256
  .amdhsa_group_segment_fixed_size 0
  .amdhsa_kernarg_size 104
  .amdhsa_user_sgpr_count 2
  .amdhsa_user_sgpr_kernarg_segment_ptr 1
  .amdhsa_system_sgpr_workgroup_id_x 1
.end_amdhsa_kernel
```
